```python
import torch

def _softmax(x, axis=-1):
    return torch.softmax(x, dim=axis)
def _gelu(x):
    return torch.nn.functional.gelu(x, approximate="tanh")
def _silu(x):
    return torch.nn.functional.silu(x)
def _sigmoid(x):
    return torch.sigmoid(x)
def _layernorm(x, axis=-1, eps=1e-5):
    m = x.mean(dim=axis, keepdim=True)
    v = x.var(dim=axis, keepdim=True, unbiased=False)
    return (x - m) / torch.sqrt(v + eps)
def _scatter_add(tgt, idx, src, axis=0):
    return tgt.clone().index_add_(axis, idx, src)
def _segment_sum(src, seg, n):
    out = torch.zeros((n,) + src.shape[1:], dtype=src.dtype)
    return out.index_add_(0, seg, src)
def _pad(x, pw):
    flat = tuple(v for pair in reversed(pw) for v in pair)
    return torch.nn.functional.pad(x, flat)

kernel_name = 'recurrent_scan__compressed_kv_cla__mixer_channel_mlp__decode'

def setup_inputs():

    _w = (lambda a: (lambda t: t.to(torch.bfloat16) if t.is_floating_point() else t)(torch.as_tensor(a)))
    def _A_setup():
        B, H, Sq, Sk, D, M = 1, 32, 1, 8192, 128, 512
        Dc = 4 * D
        return {
            "x": _w((lambda *s: torch.randn(*s, dtype=torch.bfloat16) * 0.1)(B, Sq, M)),
            "c_kv": _w((lambda *s: torch.randn(*s, dtype=torch.bfloat16) * 3.2)(B, Sk, Dc)),
            "w_q": _w((lambda *s: torch.randn(*s, dtype=torch.bfloat16) * 0.8)(M, H, D) * (M ** -0.5)),
            "w_uk": _w((lambda *s: torch.randn(*s, dtype=torch.bfloat16) * 0.8)(Dc, H, D) * (Dc ** -0.5)),
            "w_uv": _w((lambda *s: torch.randn(*s, dtype=torch.bfloat16) * 3.2)(Dc, H, D) * (Dc ** -0.5)),
            "w_o": _w((lambda *s: torch.randn(*s, dtype=torch.bfloat16) * 3.2)(H, D, M) * ((H * D) ** -0.5)),
        }
    _A_in = _A_setup()

    def _B_setup():
        B, S, D, F = 1, 1, 512, 1376
        return {
            "x": _w((lambda *s: torch.randn(*s, dtype=torch.bfloat16) * 0.1)(B, S, D)),
            "w1": _w((lambda *s: torch.randn(*s, dtype=torch.bfloat16) * 3.2)(D, F) * (D ** -0.5)),
            "b1": _w((lambda *s: torch.randn(*s, dtype=torch.bfloat16) * 3.2)(F)),
            "w2": _w((lambda *s: torch.randn(*s, dtype=torch.bfloat16) * 3.2)(F, D) * (F ** -0.5)),
            "b2": _w((lambda *s: torch.randn(*s, dtype=torch.bfloat16) * 3.2)(D)),
        }
    _B_in = _B_setup()

    return {
        "A_x": _A_in["x"],
        "A_c_kv": _A_in["c_kv"],
        "A_w_q": _A_in["w_q"],
        "A_w_uk": _A_in["w_uk"],
        "A_w_uv": _A_in["w_uv"],
        "A_w_o": _A_in["w_o"],
        "B_x": _B_in["x"],
        "B_w1": _B_in["w1"],
        "B_b1": _B_in["b1"],
        "B_w2": _B_in["w2"],
        "B_b2": _B_in["b2"],
    }

def reference(A_x, A_c_kv, A_w_q, A_w_uk, A_w_uv, A_w_o, B_x, B_w1, B_b1, B_w2, B_b2):
    def _A_ref(x, c_kv, w_q, w_uk, w_uv, w_o):
        B, Sq, M = x.shape[0], x.shape[1], x.shape[2]
        Sk = c_kv.shape[1]
        H, D = w_q.shape[1], w_q.shape[2]
        q = torch.einsum("bqm,mhd->bhqd", x, w_q)
        k = torch.einsum("bkc,chd->bhkd", c_kv, w_uk)
        v = torch.einsum("bkc,chd->bhkd", c_kv, w_uv)
        scores = torch.einsum("bhqd,bhkd->bhqk", q, k) * (D ** -0.5)
        off = Sk - Sq
        qi = torch.arange(Sq)[:, None]
        kj = torch.arange(Sk)[None, :]
        cmask = kj <= (qi + off)
        scores = torch.where(cmask[None, None], scores, -1e9)
        p = _softmax(scores, axis=-1)
        ctx = torch.einsum("bhqk,bhkd->bhqd", p, v)
        return torch.einsum("bhqd,hdm->bqm", ctx, w_o)

    def _B_ref(x, w1, b1, w2, b2):
        y = _layernorm(x, axis=-1)
        h = _gelu(torch.einsum("bsd,df->bsf", y, w1) + b1)
        return torch.einsum("bsf,fd->bsd", h, w2) + b2

    x = A_x
    xn = _layernorm(x, axis=-1)
    s = _A_ref(xn, A_c_kv, A_w_q, A_w_uk, A_w_uv, A_w_o)
    g = _silu(_B_ref(xn, B_w1, B_b1, B_w2, B_b2))
    return x + s * g
```

```asm
; @launch grid=(256,1,1) block=(256,1,1) lds=156672
.amdgcn_target "amdgcn-amd-amdhsa--gfx950"
.text
.p2align 12
.globl recurrent_scan__compressed_kv_cla__mixer_channel_mlp__decode_kernel
.p2align 8
.type recurrent_scan__compressed_kv_cla__mixer_channel_mlp__decode_kernel,@function
recurrent_scan__compressed_kv_cla__mixer_channel_mlp__decode_kernel:
    s_load_dwordx16 s[8:23], s[0:1], 0
    s_load_dwordx8 s[24:31], s[0:1], 64
    s_load_dwordx4 s[32:35], s[0:1], 96
    s_cmp_ge_u32 s2, 256
    s_cbranch_scc1 L_end
    v_lshrrev_b32 v1, 6, v0
    v_and_b32 v0, 63, v0
    v_readfirstlane_b32 s3, v1
    s_and_b32 s4, s2, 7
    s_lshr_b32 s5, s2, 3
    s_mov_b32 s64, 0
    v_lshrrev_b32 v2, 4, v0
    v_and_b32 v3, 15, v0
    v_lshlrev_b32 v4, 4, v0
    v_and_b32 v7, 3, v0
    v_bfe_u32 v1, v0, 2, 2
    s_getpc_b64 s[36:37]
L_pc:
    s_and_b32 s36, s36, 0xffffff00
    s_lshl_b32 s6, s5, 2
    s_add_u32 s6, s6, s3
    s_mul_i32 s6, s6, 192
    s_min_u32 s6, s6, L_last-recurrent_scan__compressed_kv_cla__mixer_channel_mlp__decode_kernel-128
    v_lshl_add_u32 v9, v0, 6, s6
    s_mov_b64 exec, 7
    global_load_dword v255, v9, s[36:37]
    s_mov_b64 exec, -1
    s_and_b32 s66, s5, 3
    s_lshl_b32 s6, s4, 2
    s_add_u32 s66, s66, s6
    s_bfe_u32 s67, s5, 0x20002
    s_lshl_b32 s6, s67, 2
    s_add_u32 s6, s6, s3
    s_lshl_b32 s68, s6, 5
    s_and_b32 s7, s5, 3
    s_lshl_b32 s7, s7, 3
    s_add_u32 s60, s7, s4
    s_lshl_b32 s6, s68, 13
    s_lshl_b32 s7, s60, 8
    s_add_u32 s69, s6, s7
    v_lshlrev_b32 v6, 15, v1
    v_lshl_add_u32 v6, v2, 6, v6
    v_lshl_add_u32 v6, v7, 4, v6
    v_add_u32 v6, s69, v6
    v_lshrrev_b32 v11, 1, v0
    v_lshlrev_b32 v11, 13, v11
    v_and_b32 v10, 1, v0
    v_lshl_add_u32 v11, v10, 7, v11
    v_add_u32 v11, s69, v11
    s_and_b32 s6, s5, 28
    s_add_u32 s6, s6, s3
    s_lshl_b32 s69, s6, 17
    s_add_u32 s69, s69, s7
    s_lshl_b32 s6, s6, 5
    v_lshlrev_b32 v5, 15, v2
    v_lshl_add_u32 v5, v3, 4, v5
    v_add_u32 v5, s69, v5
    v_lshl_add_u32 v8, v2, 3, s6
    s_lshl_b32 s7, s66, 12
    s_lshl_b32 s6, s6, 2
    s_add_u32 s6, s6, s7
    s_add_u32 s6, s6, 917504
    v_mov_b32 v9, s6
    s_movk_i32 s7, 0x2000
    s_cmp_lt_u32 s5, 16
    s_cselect_b32 s69, 0x20000, 0
    s_mov_b32 s6, 0
    s_waitcnt lgkmcnt(0)
    s_load_dword s56, s[34:35], 0
    global_load_dword v254, v9, s[34:35] sc1
    global_load_dwordx4 v[120:123], v4, s[8:9]
    global_load_dwordx2 v[126:127], v8, s[8:9]
    s_mov_b32 s36, s12
    s_mov_b32 s37, s13
    s_mov_b32 s38, 4194304
    s_mov_b32 s39, 0x20000
    buffer_load_dwordx4 v[32:35], v5, s[36:39], s6 offen nt
    s_add_u32 s6, s6, s7
    buffer_load_dwordx4 v[36:39], v5, s[36:39], s6 offen nt
    s_add_u32 s6, s6, s7
    buffer_load_dwordx4 v[40:43], v5, s[36:39], s6 offen nt
    s_add_u32 s6, s6, s7
    buffer_load_dwordx4 v[44:47], v5, s[36:39], s6 offen nt
    s_mov_b32 s40, s14
    s_mov_b32 s41, s15
    s_mov_b32 s42, 4194304
    s_mov_b32 s43, 0x20000
    s_barrier
    s_cmp_ge_u32 s5, 16
    s_cbranch_scc1 L_ukp
    s_mov_b32 exec_hi, 0
    buffer_load_dword v254, v11, s[40:43], s69 offen
    s_mov_b32 exec_hi, -1
    s_branch L_ukd
L_ukp:
    buffer_load_dwordx4 v[64:67], v6, s[40:43], s69 offen
    s_add_u32 s69, s69, s7
    buffer_load_dwordx4 v[68:71], v6, s[40:43], s69 offen
    s_add_u32 s69, s69, s7
    buffer_load_dwordx4 v[72:75], v6, s[40:43], s69 offen
    s_add_u32 s69, s69, s7
    buffer_load_dwordx4 v[76:79], v6, s[40:43], s69 offen
L_ukd:
    s_mov_b32 s52, s34
    s_mov_b32 s53, s35
    s_mov_b32 s54, 4194304
    s_mov_b32 s55, 0x20000
    v_and_b32 v9, 1, v3
    v_cmp_eq_u32 vcc, 1, v9
    v_mov_b32 v9, 0xffff
    v_mov_b32 v172, 0xffff0000
    v_cndmask_b32 v9, v9, v172, vcc
    v_lshrrev_b32 v175, 1, v3
    v_cmp_eq_u32 vcc, 0, v175
    s_nop 1
    v_cndmask_b32 v172, 0, v9, vcc
    v_cmp_eq_u32 vcc, 1, v175
    s_nop 1
    v_cndmask_b32 v173, 0, v9, vcc
    v_cmp_eq_u32 vcc, 2, v175
    s_nop 1
    v_cndmask_b32 v174, 0, v9, vcc
    v_cmp_eq_u32 vcc, 3, v175
    s_nop 1
    v_cndmask_b32 v175, 0, v9, vcc
    s_lshl_b32 s6, s66, 3
    s_lshr_b32 s7, s5, 2
    s_add_u32 s6, s6, s7
    s_lshl_b32 s6, s6, 9
    s_add_u32 s6, s6, 917504
    v_add_u32 v105, s6, v4
    s_mov_b32 s101, 1048576
    v_and_b32 v10, 1, v2
    s_and_b32 s33, s5, 15
    s_lshl_b32 s32, s4, 2
    s_add_u32 s32, s32, s3
    s_cmp_lt_u32 s5, 16
    s_cbranch_scc1 A_setup
    s_lshl_b32 s6, s66, 12
    s_add_u32 s6, s6, 917504
    v_add_u32 v104, s6, v4
    s_lshl_b32 s6, s3, 9
    s_add_u32 s6, s6, 2048
    v_lshrrev_b32 v9, 5, v0
    v_lshl_add_u32 v9, v10, 1, v9
    v_lshl_add_u32 v9, v3, 2, v9
    v_lshl_add_u32 v97, v9, 2, s6
    v_lshlrev_b32 v9, 6, v2
    v_lshl_add_u32 v9, v7, 4, v9
    v_mov_b32 v11, 0x100
    v_cmp_eq_u32 vcc, 0, v1
    s_nop 1
    v_cndmask_b32 v98, v11, v9, vcc
    v_cmp_eq_u32 vcc, 1, v1
    s_nop 1
    v_cndmask_b32 v99, v11, v9, vcc
    v_add_u32 v98, s6, v98
    v_add_u32 v99, s6, v99
    v_mov_b32 v100, 0
    v_mov_b32 v101, 0
    v_mov_b32 v102, 0
    v_mov_b32 v103, 0
    v_add_u32 v9, s6, v11
    ds_write_b128 v9, v[100:103]
    s_lshl_b32 s6, s66, 9
    s_add_u32 s6, s6, s68
    s_lshl_b32 s6, s6, 2
    s_add_u32 s6, s6, 131072
    v_lshlrev_b32 v9, 4, v2
    v_lshl_add_u32 v9, v1, 6, v9
    v_add_u32 v106, s6, v9
    s_lshl_b32 s6, s66, 12
    s_lshl_b32 s7, s68, 3
    s_add_u32 s6, s6, s7
    s_add_u32 s6, s6, 786432
    v_lshlrev_b32 v9, 20, v2
    v_lshl_add_u32 v9, v3, 4, v9
    v_add_u32 v9, s6, v9
    s_mov_b32 exec_hi, 0
    buffer_store_dwordx4 v[100:103], v9, s[52:55], 0 offen sc1
    s_mov_b32 exec_lo, 0x00110011
    s_mov_b32 exec_hi, 0x00110011
    buffer_store_dwordx4 v[100:103], v106, s[52:55], 0 offen sc1
    s_mov_b64 exec, -1
    s_lshl_b32 s12, s33, 1
    s_add_u32 s12, s12, s3
    s_add_u32 s12, s12, 10
    s_add_u32 s6, s33, 37
    s_cmp_lt_u32 s33, 7
    s_cselect_b32 s6, s6, 99
    s_cmp_eq_u32 s3, 2
    s_cselect_b32 s6, s6, 99
    s_cmp_lt_u32 s3, 2
    s_cselect_b32 s12, s12, s6
    s_lshl_b32 s6, s33, 2
    s_add_u32 s6, s6, s3
    s_cmp_lt_u32 s33, 5
    s_cselect_b32 s12, s6, s12
    s_and_b32 s13, s12, 3
    s_lshl_b32 s6, s4, 2
    s_add_u32 s13, s13, s6
    s_lshr_b32 s12, s12, 2
    s_lshl_b32 s6, s12, 5
    s_add_u32 s6, s6, s13
    s_lshl_b32 s6, s6, 9
    s_add_u32 s6, s6, 327680
    v_add_u32 v116, s6, v4
    s_mul_i32 s6, s13, 44032
    s_lshl_b32 s7, s12, 8
    s_add_u32 s6, s6, s7
    v_mul_u32_u24 v112, 11008, v2
    v_lshl_add_u32 v112, v3, 4, v112
    v_add_u32 v112, s6, v112
    v_add_u32 v113, 5504, v112
    s_lshl_b32 s6, s13, 5
    v_lshl_add_u32 v114, v2, 3, s6
    global_load_dwordx2 v[166:167], v114, s[8:9]
    s_mov_b32 s48, s22
    s_mov_b32 s49, s23
    s_mov_b32 s50, 1409024
    s_mov_b32 s51, 0x20000
    s_cmp_lt_u32 s12, 11
    s_cselect_b32 s50, s50, 0
    s_mov_b32 s36, s10
    s_mov_b32 s37, s11
    s_mov_b32 s38, 8388608
    s_mov_b32 s39, 0x20000
    s_lshr_b32 s6, s33, 1
    s_lshl_b32 s7, s4, 3
    s_add_u32 s6, s6, s7
    s_lshl_b32 s6, s6, 2
    s_add_u32 s6, s6, s3
    s_lshl_b32 s6, s6, 15
    s_and_b32 s7, s33, 1
    s_lshl_b32 s7, s7, 14
    s_add_u32 s6, s6, s7
    s_add_u32 s6, s6, 11264
    v_lshl_add_u32 v117, v0, 7, s6
    v_add_u32 v118, 0x1000, v117
    v_mov_b32 v119, 0x80
    s_mov_b32 s20, 0
    s_mov_b32 s65, 0
    s_waitcnt lgkmcnt(0)
    s_add_u32 s56, s56, 1
    s_and_b32 s57, s56, 0xfff
    s_and_b32 s59, s56, 0x1fff
    s_or_b32 s59, s59, 0x4000
    s_lshl_b32 s58, s59, 16
    s_movk_i32 s62, 0xfff
    s_mov_b32 s63, 0x07060302
    s_mov_b32 s100, 0x05040100
    s_lshl_b32 s6, s3, 9
    s_add_u32 s6, s6, 0
    v_add_u32 v56, s6, v4
    v_add_u32 v57, 0, v4
    s_waitcnt vmcnt(12)
    v_lshlrev_b32 v24, 16, v120
    v_and_b32 v25, 0xffff0000, v120
    v_lshlrev_b32 v26, 16, v121
    v_and_b32 v27, 0xffff0000, v121
    v_lshlrev_b32 v28, 16, v122
    v_and_b32 v29, 0xffff0000, v122
    v_lshlrev_b32 v30, 16, v123
    v_and_b32 v31, 0xffff0000, v123
    v_add_f32 v124, v24, v25
    v_add_f32 v48, v26, v27
    v_add_f32 v49, v28, v29
    v_add_f32 v125, v30, v31
    v_add_f32 v124, v124, v48
    v_add_f32 v49, v49, v125
    v_add_f32 v124, v124, v49
    s_nop 1
    v_add_f32_dpp v124, v124, v124 quad_perm:[1,0,3,2] row_mask:0xf bank_mask:0xf
    s_nop 1
    v_add_f32_dpp v124, v124, v124 quad_perm:[2,3,0,1] row_mask:0xf bank_mask:0xf
    s_nop 1
    v_add_f32_dpp v124, v124, v124 row_ror:4 row_mask:0xf bank_mask:0xf
    s_nop 1
    v_add_f32_dpp v124, v124, v124 row_ror:8 row_mask:0xf bank_mask:0xf
    v_mov_b32 v48, v124
    s_nop 1
    v_permlane16_swap_b32 v48, v124
    v_add_f32 v124, v124, v48
    v_mov_b32 v48, v124
    s_nop 1
    v_permlane32_swap_b32 v48, v124
    v_add_f32 v124, v124, v48
    v_mul_f32 v124, 0x3b000000, v124
    v_sub_f32 v48, v24, v124
    v_mul_f32 v125, v48, v48
    v_sub_f32 v48, v25, v124
    v_fmac_f32 v125, v48, v48
    v_sub_f32 v48, v26, v124
    v_fmac_f32 v125, v48, v48
    v_sub_f32 v48, v27, v124
    v_fmac_f32 v125, v48, v48
    v_sub_f32 v48, v28, v124
    v_fmac_f32 v125, v48, v48
    v_sub_f32 v48, v29, v124
    v_fmac_f32 v125, v48, v48
    v_sub_f32 v48, v30, v124
    v_fmac_f32 v125, v48, v48
    v_sub_f32 v48, v31, v124
    v_fmac_f32 v125, v48, v48
    s_nop 1
    v_add_f32_dpp v125, v125, v125 quad_perm:[1,0,3,2] row_mask:0xf bank_mask:0xf
    s_nop 1
    v_add_f32_dpp v125, v125, v125 quad_perm:[2,3,0,1] row_mask:0xf bank_mask:0xf
    s_nop 1
    v_add_f32_dpp v125, v125, v125 row_ror:4 row_mask:0xf bank_mask:0xf
    s_nop 1
    v_add_f32_dpp v125, v125, v125 row_ror:8 row_mask:0xf bank_mask:0xf
    v_mov_b32 v48, v125
    s_nop 1
    v_permlane16_swap_b32 v48, v125
    v_add_f32 v125, v125, v48
    v_mov_b32 v48, v125
    s_nop 1
    v_permlane32_swap_b32 v48, v125
    v_add_f32 v125, v125, v48
    v_mul_f32 v125, 0x3b000000, v125
    v_cvt_pk_bf16_f32 v124, 0, v124
    v_cvt_pk_bf16_f32 v125, 0, v125
    v_add_f32 v125, 0x3727c5ac, v125
    v_cvt_pk_bf16_f32 v125, 0, v125
    v_sqrt_f32 v125, v125
    s_nop 0
    v_cvt_pk_bf16_f32 v125, 0, v125
    v_rcp_f32 v125, v125
    s_nop 0
    s_waitcnt vmcnt(11)
    v_lshlrev_b32 v24, 16, v126
    v_and_b32 v25, 0xffff0000, v126
    v_lshlrev_b32 v26, 16, v127
    v_and_b32 v27, 0xffff0000, v127
    v_sub_f32 v24, v24, v124
    v_cvt_pk_bf16_f32 v24, 0, v24
    v_mul_f32 v24, v24, v125
    v_cvt_pk_bf16_f32 v24, v24, v24
    v_sub_f32 v25, v25, v124
    v_cvt_pk_bf16_f32 v25, 0, v25
    v_mul_f32 v25, v25, v125
    v_cvt_pk_bf16_f32 v25, v25, v25
    v_sub_f32 v26, v26, v124
    v_cvt_pk_bf16_f32 v26, 0, v26
    v_mul_f32 v26, v26, v125
    v_cvt_pk_bf16_f32 v26, v26, v26
    v_sub_f32 v27, v27, v124
    v_cvt_pk_bf16_f32 v27, 0, v27
    v_mul_f32 v27, v27, v125
    v_cvt_pk_bf16_f32 v27, v27, v27
    v_and_b32 v48, v24, v172
    v_and_b32 v49, v24, v173
    v_and_b32 v50, v24, v174
    v_and_b32 v51, v24, v175
    s_waitcnt vmcnt(10)
    s_nop 0
    v_mfma_f32_16x16x32_bf16 v[108:111], v[48:51], v[32:35], 0
    v_and_b32 v52, v25, v172
    v_and_b32 v53, v25, v173
    v_and_b32 v54, v25, v174
    v_and_b32 v55, v25, v175
    s_waitcnt vmcnt(9)
    s_nop 0
    v_mfma_f32_16x16x32_bf16 v[108:111], v[52:55], v[36:39], v[108:111]
    v_and_b32 v48, v26, v172
    v_and_b32 v49, v26, v173
    v_and_b32 v50, v26, v174
    v_and_b32 v51, v26, v175
    s_waitcnt vmcnt(8)
    s_nop 0
    v_mfma_f32_16x16x32_bf16 v[108:111], v[48:51], v[40:43], v[108:111]
    v_and_b32 v52, v27, v172
    v_and_b32 v53, v27, v173
    v_and_b32 v54, v27, v174
    v_and_b32 v55, v27, v175
    s_waitcnt vmcnt(7)
    s_nop 0
    v_mfma_f32_16x16x32_bf16 v[108:111], v[52:55], v[44:47], v[108:111]
    s_mov_b32 exec_hi, 0
    s_nop 7
    ds_write_b128 v56, v[108:111]
    s_mov_b64 exec, -1
    s_waitcnt lgkmcnt(0)
    s_barrier
    s_cmp_lg_u32 s3, 0
    s_cbranch_scc1 P_nopub
    s_mov_b32 exec_hi, 0
    ds_read_b128 v[32:35], v57 offset:0
    ds_read_b128 v[36:39], v57 offset:512
    ds_read_b128 v[40:43], v57 offset:1024
    ds_read_b128 v[44:47], v57 offset:1536
    v_mov_b32 v28, s57
    s_waitcnt lgkmcnt(2)
    v_add_f32 v32, v32, v36
    v_add_f32 v33, v33, v37
    v_add_f32 v34, v34, v38
    v_add_f32 v35, v35, v39
    s_waitcnt lgkmcnt(0)
    v_add_f32 v40, v40, v44
    v_add_f32 v41, v41, v45
    v_add_f32 v42, v42, v46
    v_add_f32 v43, v43, v47
    v_add_f32 v100, v32, v40
    v_add_f32 v101, v33, v41
    v_add_f32 v102, v34, v42
    v_add_f32 v103, v35, v43
    s_movk_i32 s6, 0xff
    v_bfi_b32 v100, s6, v28, v100
    v_bfi_b32 v101, s6, v28, v101
    v_bfi_b32 v102, s6, v28, v102
    v_bfi_b32 v103, s6, v28, v103
    buffer_store_dwordx4 v[100:103], v105, s[52:55], 0 offen
    s_mov_b64 exec, -1
P_nopub:
    s_barrier
    s_mov_b32 s6, 131072
    buffer_load_dwordx4 v[80:83], v6, s[40:43], s6 offen
    s_mov_b32 s6, 139264
    buffer_load_dwordx4 v[84:87], v6, s[40:43], s6 offen
    s_mov_b32 s6, 147456
    buffer_load_dwordx4 v[88:91], v6, s[40:43], s6 offen
    s_mov_b32 s6, 155648
    buffer_load_dwordx4 v[92:95], v6, s[40:43], s6 offen
    s_waitcnt vmcnt(7)
P_polla:
P_polla2:
    buffer_load_dwordx4 v[32:35], v104, s[52:55], s65 offen offset:0 sc1
    buffer_load_dwordx4 v[36:39], v104, s[52:55], s65 offen offset:1024 sc1
    buffer_load_dwordx4 v[40:43], v104, s[52:55], s65 offen offset:2048 sc1
    buffer_load_dwordx4 v[44:47], v104, s[52:55], s65 offen offset:3072 sc1
    s_cmp_lg_u32 s20, 32
    s_cbranch_scc1 P_nofar1
    s_cmp_lg_u32 s3, 0
    s_cbranch_scc1 P_nofar1
    s_mov_b32 exec_hi, 0
    buffer_store_dwordx4 v[100:103], v105, s[52:55], s101 offen sc1
    s_mov_b64 exec, -1
    s_waitcnt vmcnt(0)
P_nofar1:
    s_add_u32 s64, s64, 1
    s_cmp_gt_u32 s64, 1048576
    s_cbranch_scc1 L_end
    s_add_u32 s20, s20, 1
    s_and_b32 s6, s20, 1
    s_cmp_gt_u32 s20, 40
    s_cselect_b32 s6, s6, 0
    s_lshl_b32 s65, s6, 20
    v_mov_b32 v9, 0
    s_movk_i32 s7, 0xff
    s_waitcnt vmcnt(3)
    v_bitop3_b32 v9, v9, v32, s57 bitop3:0xf6
    v_bfi_b32 v32, s7, v119, v32
    v_bitop3_b32 v9, v9, v33, s57 bitop3:0xf6
    v_bfi_b32 v33, s7, v119, v33
    v_bitop3_b32 v9, v9, v34, s57 bitop3:0xf6
    v_bfi_b32 v34, s7, v119, v34
    v_bitop3_b32 v9, v9, v35, s57 bitop3:0xf6
    v_bfi_b32 v35, s7, v119, v35
    s_waitcnt vmcnt(2)
    v_bitop3_b32 v9, v9, v36, s57 bitop3:0xf6
    v_bfi_b32 v36, s7, v119, v36
    v_bitop3_b32 v9, v9, v37, s57 bitop3:0xf6
    v_bfi_b32 v37, s7, v119, v37
    v_bitop3_b32 v9, v9, v38, s57 bitop3:0xf6
    v_bfi_b32 v38, s7, v119, v38
    v_bitop3_b32 v9, v9, v39, s57 bitop3:0xf6
    v_bfi_b32 v39, s7, v119, v39
    v_add_f32 v32, v32, v36
    v_add_f32 v33, v33, v37
    v_add_f32 v34, v34, v38
    v_add_f32 v35, v35, v39
    s_waitcnt vmcnt(1)
    v_bitop3_b32 v9, v9, v40, s57 bitop3:0xf6
    v_bfi_b32 v40, s7, v119, v40
    v_bitop3_b32 v9, v9, v41, s57 bitop3:0xf6
    v_bfi_b32 v41, s7, v119, v41
    v_bitop3_b32 v9, v9, v42, s57 bitop3:0xf6
    v_bfi_b32 v42, s7, v119, v42
    v_bitop3_b32 v9, v9, v43, s57 bitop3:0xf6
    v_bfi_b32 v43, s7, v119, v43
    v_add_f32 v32, v32, v40
    v_add_f32 v33, v33, v41
    v_add_f32 v34, v34, v42
    v_add_f32 v35, v35, v43
    s_waitcnt vmcnt(0)
    v_bitop3_b32 v9, v9, v44, s57 bitop3:0xf6
    v_bfi_b32 v44, s7, v119, v44
    v_bitop3_b32 v9, v9, v45, s57 bitop3:0xf6
    v_bfi_b32 v45, s7, v119, v45
    v_bitop3_b32 v9, v9, v46, s57 bitop3:0xf6
    v_bfi_b32 v46, s7, v119, v46
    v_bitop3_b32 v9, v9, v47, s57 bitop3:0xf6
    v_bfi_b32 v47, s7, v119, v47
    v_and_b32 v9, s7, v9
    v_cmp_ne_u32 vcc, 0, v9
    v_add_f32 v32, v32, v44
    v_add_f32 v33, v33, v45
    v_add_f32 v34, v34, v46
    v_add_f32 v35, v35, v47
    s_cbranch_vccnz P_polla2
    s_nop 0
    v_permlane32_swap_b32 v32, v34
    s_nop 0
    v_permlane32_swap_b32 v33, v35
    v_add_f32 v32, v32, v34
    v_add_f32 v33, v33, v35
    v_cvt_pk_bf16_f32 v32, v32, v33
    ds_write_b32 v97, v32
    ds_read_b128 v[16:19], v98
    ds_read_b128 v[20:23], v99
    s_mov_b32 exec_hi, 0xff
    buffer_load_dword v248, v117, s[36:39], 0 offen
    s_mov_b32 exec_hi, -1
    s_waitcnt lgkmcnt(1)
    v_mfma_f32_16x16x32_bf16 v[32:35], v[64:67], v[16:19], 0
    v_mfma_f32_16x16x32_bf16 v[36:39], v[68:71], v[16:19], 0
    v_mfma_f32_16x16x32_bf16 v[40:43], v[72:75], v[16:19], 0
    v_mfma_f32_16x16x32_bf16 v[44:47], v[76:79], v[16:19], 0
    s_waitcnt lgkmcnt(0)
    v_mfma_f32_16x16x32_bf16 v[32:35], v[80:83], v[20:23], v[32:35]
    v_mfma_f32_16x16x32_bf16 v[36:39], v[84:87], v[20:23], v[36:39]
    v_mfma_f32_16x16x32_bf16 v[40:43], v[88:91], v[20:23], v[40:43]
    v_mfma_f32_16x16x32_bf16 v[44:47], v[92:95], v[20:23], v[44:47]
    s_nop 4
    v_add_f32_dpp v16, v33, v32 quad_perm:[1,1,1,1] row_mask:0xf bank_mask:0xf
    v_add_f32_dpp v17, v37, v36 quad_perm:[1,1,1,1] row_mask:0xf bank_mask:0xf
    v_add_f32_dpp v18, v41, v40 quad_perm:[1,1,1,1] row_mask:0xf bank_mask:0xf
    v_add_f32_dpp v19, v45, v44 quad_perm:[1,1,1,1] row_mask:0xf bank_mask:0xf
    v_add_f32_dpp v16, v34, v16 quad_perm:[2,2,2,2] row_mask:0xf bank_mask:0xf
    v_add_f32_dpp v17, v38, v17 quad_perm:[2,2,2,2] row_mask:0xf bank_mask:0xf
    v_add_f32_dpp v18, v42, v18 quad_perm:[2,2,2,2] row_mask:0xf bank_mask:0xf
    v_add_f32_dpp v19, v46, v19 quad_perm:[2,2,2,2] row_mask:0xf bank_mask:0xf
    v_add_f32_dpp v16, v35, v16 quad_perm:[3,3,3,3] row_mask:0xf bank_mask:0xf
    v_add_f32_dpp v17, v39, v17 quad_perm:[3,3,3,3] row_mask:0xf bank_mask:0xf
    v_add_f32_dpp v18, v43, v18 quad_perm:[3,3,3,3] row_mask:0xf bank_mask:0xf
    v_add_f32_dpp v19, v47, v19 quad_perm:[3,3,3,3] row_mask:0xf bank_mask:0xf
    v_cvt_pk_bf16_f32 v16, s58, v16
    v_cvt_pk_bf16_f32 v17, s58, v17
    v_cvt_pk_bf16_f32 v18, s58, v18
    v_cvt_pk_bf16_f32 v19, s58, v19
    s_mov_b32 exec_lo, 0x00110011
    s_mov_b32 exec_hi, 0x00110011
    buffer_store_dwordx4 v[16:19], v106, s[52:55], 0 offen sc1
    s_mov_b64 exec, -1
    s_barrier
    s_cmp_lg_u32 s3, 0
    s_cbranch_scc1 P_nofar2
    s_mov_b32 exec_hi, 0
    buffer_store_dwordx4 v[100:103], v105, s[52:55], s101 offen sc1
    s_mov_b64 exec, -1
P_nofar2:
    s_lshl_b32 s6, s33, 2
    s_add_u32 s6, s6, s3
    s_lshl_b32 s7, s6, 9
    s_lshl_b32 s21, s4, 6
    s_add_u32 s7, s7, s21
    s_add_u32 s7, s7, 196608
    v_mov_b32 v9, s7
    s_lshl_b32 s7, s4, 12
    s_lshl_b32 vcc_lo, s6, 6
    s_add_u32 s7, s7, vcc_lo
    s_add_u32 s7, s7, 196608
    v_mov_b32 v9, s7
    s_lshr_b32 s7, s6, 1
    s_lshl_b32 s7, s7, 11
    s_and_b32 s6, s6, 1
    s_lshl_b32 s6, s6, 7
    s_add_u32 s7, s7, s6
    s_lshl_b32 s21, s21, 2
    s_add_u32 s7, s7, s21
    s_lshl_b32 s6, s66, 11
    s_lshl_b32 s21, s67, 8
    s_add_u32 s6, s6, s21
    s_and_b32 s21, s3, 1
    s_lshl_b32 s21, s21, 7
    s_add_u32 s6, s6, s21
    s_lshr_b32 s21, s3, 1
    s_lshl_b32 s21, s21, 10
    s_add_u32 s6, s6, s21
    s_add_u32 s6, s6, 262144
    v_writelane_b32 v9, s6, 1
    v_writelane_b32 v9, s6, 2
    s_mov_b64 exec, 7
    buffer_load_dword v254, v9, s[52:55], 0 offen sc1
    s_mov_b64 exec, -1
    s_lshl_b32 s6, s4, 7
    v_mov_b32 v9, s6
    s_mov_b64 exec, 1
    global_load_dword v254, v9, s[28:29]
    s_mov_b64 exec, -1
    buffer_load_dwordx4 v[144:147], v112, s[48:51], 0 offen offset:0 nt
    buffer_load_dwordx4 v[148:151], v112, s[48:51], 0 offen offset:2752 nt
    buffer_load_dwordx4 v[152:155], v113, s[48:51], 0 offen offset:0 nt
    buffer_load_dwordx4 v[156:159], v113, s[48:51], 0 offen offset:2752 nt
    v_lshlrev_b32 v24, 16, v120
    v_and_b32 v25, 0xffff0000, v120
    v_lshlrev_b32 v26, 16, v121
    v_and_b32 v27, 0xffff0000, v121
    v_lshlrev_b32 v28, 16, v122
    v_and_b32 v29, 0xffff0000, v122
    v_lshlrev_b32 v30, 16, v123
    v_and_b32 v31, 0xffff0000, v123
    v_sub_f32 v24, v24, v124
    v_cvt_pk_bf16_f32 v24, 0, v24
    v_mul_f32 v24, v24, v125
    v_cvt_pk_bf16_f32 v24, 0, v24
    v_sub_f32 v25, v25, v124
    v_cvt_pk_bf16_f32 v25, 0, v25
    v_mul_f32 v25, v25, v125
    v_cvt_pk_bf16_f32 v25, 0, v25
    v_sub_f32 v26, v26, v124
    v_cvt_pk_bf16_f32 v26, 0, v26
    v_mul_f32 v26, v26, v125
    v_cvt_pk_bf16_f32 v26, 0, v26
    v_sub_f32 v27, v27, v124
    v_cvt_pk_bf16_f32 v27, 0, v27
    v_mul_f32 v27, v27, v125
    v_cvt_pk_bf16_f32 v27, 0, v27
    v_sub_f32 v28, v28, v124
    v_cvt_pk_bf16_f32 v28, 0, v28
    v_mul_f32 v28, v28, v125
    v_cvt_pk_bf16_f32 v28, 0, v28
    v_sub_f32 v29, v29, v124
    v_cvt_pk_bf16_f32 v29, 0, v29
    v_mul_f32 v29, v29, v125
    v_cvt_pk_bf16_f32 v29, 0, v29
    v_sub_f32 v30, v30, v124
    v_cvt_pk_bf16_f32 v30, 0, v30
    v_mul_f32 v30, v30, v125
    v_cvt_pk_bf16_f32 v30, 0, v30
    v_sub_f32 v31, v31, v124
    v_cvt_pk_bf16_f32 v31, 0, v31
    v_mul_f32 v31, v31, v125
    v_cvt_pk_bf16_f32 v31, 0, v31
    v_add_f32 v120, v24, v25
    v_add_f32 v48, v26, v27
    v_add_f32 v49, v28, v29
    v_add_f32 v121, v30, v31
    v_add_f32 v120, v120, v48
    v_add_f32 v49, v49, v121
    v_add_f32 v120, v120, v49
    s_nop 1
    v_add_f32_dpp v120, v120, v120 quad_perm:[1,0,3,2] row_mask:0xf bank_mask:0xf
    s_nop 1
    v_add_f32_dpp v120, v120, v120 quad_perm:[2,3,0,1] row_mask:0xf bank_mask:0xf
    s_nop 1
    v_add_f32_dpp v120, v120, v120 row_ror:4 row_mask:0xf bank_mask:0xf
    s_nop 1
    v_add_f32_dpp v120, v120, v120 row_ror:8 row_mask:0xf bank_mask:0xf
    v_mov_b32 v48, v120
    s_nop 1
    v_permlane16_swap_b32 v48, v120
    v_add_f32 v120, v120, v48
    v_mov_b32 v48, v120
    s_nop 1
    v_permlane32_swap_b32 v48, v120
    v_add_f32 v120, v120, v48
    v_mul_f32 v120, 0x3b000000, v120
    v_sub_f32 v48, v24, v120
    v_mul_f32 v121, v48, v48
    v_sub_f32 v48, v25, v120
    v_fmac_f32 v121, v48, v48
    v_sub_f32 v48, v26, v120
    v_fmac_f32 v121, v48, v48
    v_sub_f32 v48, v27, v120
    v_fmac_f32 v121, v48, v48
    v_sub_f32 v48, v28, v120
    v_fmac_f32 v121, v48, v48
    v_sub_f32 v48, v29, v120
    v_fmac_f32 v121, v48, v48
    v_sub_f32 v48, v30, v120
    v_fmac_f32 v121, v48, v48
    v_sub_f32 v48, v31, v120
    v_fmac_f32 v121, v48, v48
    s_nop 1
    v_add_f32_dpp v121, v121, v121 quad_perm:[1,0,3,2] row_mask:0xf bank_mask:0xf
    s_nop 1
    v_add_f32_dpp v121, v121, v121 quad_perm:[2,3,0,1] row_mask:0xf bank_mask:0xf
    s_nop 1
    v_add_f32_dpp v121, v121, v121 row_ror:4 row_mask:0xf bank_mask:0xf
    s_nop 1
    v_add_f32_dpp v121, v121, v121 row_ror:8 row_mask:0xf bank_mask:0xf
    v_mov_b32 v48, v121
    s_nop 1
    v_permlane16_swap_b32 v48, v121
    v_add_f32 v121, v121, v48
    v_mov_b32 v48, v121
    s_nop 1
    v_permlane32_swap_b32 v48, v121
    v_add_f32 v121, v121, v48
    v_mul_f32 v121, 0x3b000000, v121
    v_cvt_pk_bf16_f32 v120, 0, v120
    v_cvt_pk_bf16_f32 v121, 0, v121
    v_add_f32 v121, 0x3727c5ac, v121
    v_cvt_pk_bf16_f32 v121, 0, v121
    v_sqrt_f32 v121, v121
    s_nop 0
    v_cvt_pk_bf16_f32 v121, 0, v121
    v_rcp_f32 v121, v121
    s_nop 0
    v_lshlrev_b32 v24, 16, v166
    v_and_b32 v25, 0xffff0000, v166
    v_lshlrev_b32 v26, 16, v167
    v_and_b32 v27, 0xffff0000, v167
    v_sub_f32 v24, v24, v124
    v_cvt_pk_bf16_f32 v24, 0, v24
    v_mul_f32 v24, v24, v125
    v_cvt_pk_bf16_f32 v24, 0, v24
    v_sub_f32 v24, v24, v120
    v_cvt_pk_bf16_f32 v24, 0, v24
    v_mul_f32 v24, v24, v121
    v_cvt_pk_bf16_f32 v24, v24, v24
    v_sub_f32 v25, v25, v124
    v_cvt_pk_bf16_f32 v25, 0, v25
    v_mul_f32 v25, v25, v125
    v_cvt_pk_bf16_f32 v25, 0, v25
    v_sub_f32 v25, v25, v120
    v_cvt_pk_bf16_f32 v25, 0, v25
    v_mul_f32 v25, v25, v121
    v_cvt_pk_bf16_f32 v25, v25, v25
    v_sub_f32 v26, v26, v124
    v_cvt_pk_bf16_f32 v26, 0, v26
    v_mul_f32 v26, v26, v125
    v_cvt_pk_bf16_f32 v26, 0, v26
    v_sub_f32 v26, v26, v120
    v_cvt_pk_bf16_f32 v26, 0, v26
    v_mul_f32 v26, v26, v121
    v_cvt_pk_bf16_f32 v26, v26, v26
    v_sub_f32 v27, v27, v124
    v_cvt_pk_bf16_f32 v27, 0, v27
    v_mul_f32 v27, v27, v125
    v_cvt_pk_bf16_f32 v27, 0, v27
    v_sub_f32 v27, v27, v120
    v_cvt_pk_bf16_f32 v27, 0, v27
    v_mul_f32 v27, v27, v121
    v_cvt_pk_bf16_f32 v27, v27, v27
    v_and_b32 v200, v24, v172
    v_and_b32 v201, v24, v173
    v_and_b32 v202, v24, v174
    v_and_b32 v203, v24, v175
    v_and_b32 v204, v25, v172
    v_and_b32 v205, v25, v173
    v_and_b32 v206, v25, v174
    v_and_b32 v207, v25, v175
    v_and_b32 v208, v26, v172
    v_and_b32 v209, v26, v173
    v_and_b32 v210, v26, v174
    v_and_b32 v211, v26, v175
    v_and_b32 v212, v27, v172
    v_and_b32 v213, v27, v173
    v_and_b32 v214, v27, v174
    v_and_b32 v215, v27, v175
    s_lshl_b32 s6, s33, 18
    s_lshl_b32 s7, s3, 3
    s_add_u32 s7, s7, s4
    s_lshl_b32 s7, s7, 8
    s_add_u32 s6, s6, s7
    v_lshlrev_b32 v115, 4, v3
    v_lshl_add_u32 v115, v10, 17, v115
    v_lshrrev_b32 v9, 1, v2
    v_lshl_add_u32 v115, v9, 15, v115
    v_add_u32 v115, s6, v115
    s_mov_b32 s44, s16
    s_mov_b32 s45, s17
    s_mov_b32 s46, 4194304
    s_mov_b32 s47, 0x20000
    v_mov_b32 v14, s57
    s_mul_i32 s14, s4, 11
    s_add_u32 s14, s14, s33
    s_sub_u32 s14, s14, 5
    s_cmp_ge_u32 s33, 5
    s_cselect_b32 s14, s14, 99
    s_lshr_b32 s15, s14, 1
    s_lshl_b32 s15, s15, 5
    s_and_b32 s6, s14, 1
    s_lshl_b32 s7, s6, 2
    s_add_u32 s15, s15, s7
    s_lshl_b32 s6, s6, 8
    s_lshr_b32 s7, s14, 3
    s_lshl_b32 s7, s7, 14
    s_add_u32 s6, s6, s7
    s_and_b32 s7, s14, 6
    s_lshl_b32 s7, s7, 5
    s_add_u32 s6, s6, s7
    s_lshl_b32 s7, s3, 12
    s_add_u32 s6, s6, s7
    s_add_u32 s6, s6, 327680
    s_cmp_lt_u32 s14, 86
    s_cselect_b32 s6, s6, 4194304
    v_bfe_u32 v169, v0, 2, 3
    v_lshlrev_b32 v169, 9, v169
    v_lshl_add_u32 v169, v7, 4, v169
    v_add_u32 v169, s6, v169
    s_lshl_b32 s7, s15, 1
    v_lshl_add_u32 v170, v7, 3, v2
    v_lshl_add_u32 v170, v170, 1, s7
    v_mov_b32 v164, 0
    s_lshl_b32 s6, s15, 10
    s_lshl_b32 s7, s3, 8
    s_add_u32 s6, s6, s7
    v_lshlrev_b32 v171, 10, v2
    v_lshl_add_u32 v171, v3, 4, v171
    v_add_u32 v171, s6, v171
    s_lshl_b32 s6, s60, 17
    s_lshl_b32 s7, s3, 15
    s_add_u32 s6, s6, s7
    s_lshl_b32 s7, s67, 7
    s_add_u32 s6, s6, s7
    v_lshlrev_b32 v9, 3, v10
    v_xor_b32 v9, v9, v3
    v_lshlrev_b32 v9, 4, v9
    v_and_b32 v11, 0x80, v9
    v_mul_u32_u24 v11, 3, v11
    v_add_u32 v9, v9, v11
    v_lshl_add_u32 v243, v2, 13, v9
    v_add_u32 v243, s6, v243
    s_lshl_b32 s6, s66, 11
    s_add_u32 s6, s6, 131072
    v_lshrrev_b32 v118, 2, v0
    v_lshlrev_b32 v118, 7, v118
    v_lshl_add_u32 v118, v7, 2, v118
    v_add_u32 v118, s6, v118
    s_mov_b32 s36, s26
    s_mov_b32 s37, s27
    s_mov_b32 s38, 1409024
    s_mov_b32 s39, 0x20000
    s_mov_b32 s40, s24
    s_mov_b32 s41, s25
    s_mov_b32 s42, 2752
    s_mov_b32 s43, 0x20000
    s_mul_i32 s6, s3, 8448
    s_add_u32 s6, s6, 8192
    s_mov_b32 m0, s6
    s_mov_b32 s6, 65536
    buffer_load_dwordx4 v[248:251], v115, s[44:47], s6 offen
    s_mov_b32 s6, 73728
    buffer_load_dwordx4 v[248:251], v115, s[44:47], s6 offen
    s_mov_b32 s6, 81920
    buffer_load_dwordx4 v[248:251], v115, s[44:47], s6 offen
    s_cmp_ge_u32 s12, 11
    s_cbranch_scc1 P_nohid
    s_waitcnt vmcnt(3)
    v_mfma_f32_16x16x32_bf16 v[28:31], v[200:203], v[144:147], 0
    v_mfma_f32_16x16x32_bf16 v[28:31], v[204:207], v[148:151], v[28:31]
    v_mfma_f32_16x16x32_bf16 v[28:31], v[208:211], v[152:155], v[28:31]
    v_mfma_f32_16x16x32_bf16 v[28:31], v[212:215], v[156:159], v[28:31]
    s_nop 7
    v_bfi_b32 v28, s62, v14, v28
    v_bfi_b32 v29, s62, v14, v29
    v_bfi_b32 v30, s62, v14, v30
    v_bfi_b32 v31, s62, v14, v31
    s_mov_b32 exec_hi, 0
    buffer_store_dwordx4 v[28:31], v116, s[52:55], 0 offen sc1
    s_mov_b64 exec, -1
P_nohid:
    s_barrier
    s_mov_b32 s6, 90112
    buffer_load_dwordx4 v[248:251], v115, s[44:47], s6 offen
    s_mov_b32 s48, s18
    s_mov_b32 s49, s19
    s_mov_b32 s50, 4194304
    s_mov_b32 s51, 0x20000
    buffer_load_short_d16_hi v164, v170, s[40:43], 0 offen
    s_mov_b32 s6, 0
    buffer_load_dwordx4 v[144:147], v171, s[36:39], s6 offen nt
    s_mov_b32 s6, 8192
    buffer_load_dwordx4 v[148:151], v171, s[36:39], s6 offen nt
    s_mov_b32 s6, 16384
    buffer_load_dwordx4 v[152:155], v171, s[36:39], s6 offen nt
    s_mov_b32 s6, 24576
    buffer_load_dwordx4 v[156:159], v171, s[36:39], s6 offen nt
    s_mov_b32 s6, 0
    buffer_load_dwordx4 v243, s[48:51], s6 offen nt lds
    s_add_u32 m0, m0, 1056
    s_mov_b32 s6, 1024
    buffer_load_dwordx4 v243, s[48:51], s6 offen nt lds
    s_add_u32 m0, m0, 1056
    s_mov_b32 s6, 2048
    buffer_load_dwordx4 v243, s[48:51], s6 offen nt lds
    s_add_u32 m0, m0, 1056
    s_waitcnt vmcnt(3)
    buffer_load_dword v19, v118, s[52:55], 0 offen sc1
    buffer_load_dwordx4 v[192:195], v169, s[52:55], 0 offen sc1
    s_barrier
    s_mov_b32 s6, 3072
    buffer_load_dwordx4 v243, s[48:51], s6 offen nt lds
    s_add_u32 m0, m0, 1056
    s_mov_b32 s6, 4096
    buffer_load_dwordx4 v243, s[48:51], s6 offen nt lds
    s_add_u32 m0, m0, 1056
    s_mov_b32 s6, 5120
    buffer_load_dwordx4 v243, s[48:51], s6 offen nt lds
    s_add_u32 m0, m0, 1056
    s_mov_b32 s6, 6144
    buffer_load_dwordx4 v243, s[48:51], s6 offen nt lds
    s_add_u32 m0, m0, 1056
    s_mov_b32 s6, 7168
    buffer_load_dwordx4 v243, s[48:51], s6 offen nt lds
    s_add_u32 m0, m0, 1056
    s_lshl_b32 s6, s66, 12
    s_add_u32 s6, s6, 786432
    v_add_u32 v117, s6, v4
    v_mul_u32_u24 v11, 1056, v1
    v_lshl_add_u32 v11, v2, 8, v11
    v_lshl_add_u32 v11, v7, 3, v11
    v_lshlrev_b32 v9, 7, v10
    s_lshl_b32 s6, s3, 6
    v_xor_b32 v9, s6, v9
    v_add_u32 v9, 8192, v9
    v_add_u32 v100, v11, v9
    s_lshl_b32 s6, s66, 11
    s_lshl_b32 s7, s67, 8
    s_add_u32 s6, s6, s7
    s_and_b32 s7, s3, 1
    s_lshl_b32 s7, s7, 7
    s_add_u32 s6, s6, s7
    s_lshr_b32 s7, s3, 1
    s_lshl_b32 s7, s7, 10
    s_add_u32 s6, s6, s7
    s_add_u32 s6, s6, 262144
    v_lshrrev_b32 v9, 5, v0
    v_lshlrev_b32 v9, 6, v9
    v_lshl_add_u32 v9, v3, 4, v9
    v_add_u32 v15, s6, v9
    s_mov_b32 s20, 0
    s_mov_b32 s65, 0
    s_cmp_ge_u32 s14, 86
    s_cbranch_scc1 P_nomlp
    s_waitcnt vmcnt(5)
    s_branch M_poll_have
M_poll:
    s_mov_b32 s6, 0
    buffer_load_dwordx4 v[192:195], v169, s[52:55], s6 offen sc1
    s_add_u32 s64, s64, 1
    s_cmp_gt_u32 s64, 1048576
    s_cbranch_scc1 L_end
    s_waitcnt vmcnt(0)
M_poll_have:
    v_mov_b32 v196, 0
    v_mov_b32 v197, 0x800
    v_bitop3_b32 v196, v196, v192, s57 bitop3:0xf6
    v_bitop3_b32 v196, v196, v193, s57 bitop3:0xf6
    v_bitop3_b32 v196, v196, v194, s57 bitop3:0xf6
    v_bitop3_b32 v196, v196, v195, s57 bitop3:0xf6
    v_and_b32 v196, s62, v196
    v_cmp_ne_u32 vcc, 0, v196
    s_cbranch_vccnz M_poll
    v_bfi_b32 v192, s62, v197, v192
    v_bfi_b32 v193, s62, v197, v193
    v_bfi_b32 v194, s62, v197, v194
    v_bfi_b32 v195, s62, v197, v195
    s_nop 1
    v_permlane32_swap_b32 v192, v194
    v_permlane32_swap_b32 v193, v195
    v_add_f32 v192, v192, v194
    v_add_f32 v193, v193, v195
    s_nop 1
    v_permlane16_swap_b32 v192, v193
    v_add_f32 v48, v192, v193
    s_nop 1
    v_add_f32_dpp v48, v48, v48 row_ror:4 row_mask:0xf bank_mask:0xf
    s_nop 1
    v_add_f32_dpp v48, v48, v48 row_ror:8 row_mask:0xf bank_mask:0xf
    v_lshl_add_u32 v9, v2, 2, v7
    v_lshlrev_b32 v9, 4, v9
    v_add_u32 v9, 4096, v9
    s_lshl_b32 s6, s3, 2
    v_add_u32 v11, s6, v9
    ds_write_b32 v11, v48
    s_waitcnt lgkmcnt(0)
    s_barrier
    ds_read_b128 v[48:51], v9
    s_waitcnt lgkmcnt(0)
    v_add_f32 v48, v48, v49
    v_add_f32 v50, v50, v51
    v_add_f32 v48, v48, v50
    v_mul_f32 v48, 0.5, v48
    s_mov_b32 s6, 0xbdd2d3e8
    v_mov_b32 v52, 0xc0135761
    v_cvt_pk_bf16_f32 v48, 0, v48
    v_add_f32 v48, v48, v164
    v_cvt_pk_bf16_f32 v48, 0, v48
    v_mul_f32 v53, v48, v48
    v_fma_f32 v53, v53, s6, v52
    v_mul_f32 v53, v53, v48
    v_exp_f32 v53, v53
    s_nop 0
    v_add_f32 v53, 1.0, v53
    v_rcp_f32 v53, v53
    s_nop 0
    v_mul_f32 v48, v48, v53
    v_cvt_pk_bf16_f32 v48, v48, v48
    s_nop 1
    v_and_b32_dpp v32, v48, v172 quad_perm:[0,0,0,0] row_mask:0xf bank_mask:0xf
    v_and_b32_dpp v33, v48, v173 quad_perm:[0,0,0,0] row_mask:0xf bank_mask:0xf
    v_and_b32_dpp v34, v48, v174 quad_perm:[0,0,0,0] row_mask:0xf bank_mask:0xf
    v_and_b32_dpp v35, v48, v175 quad_perm:[0,0,0,0] row_mask:0xf bank_mask:0xf
    v_and_b32_dpp v36, v48, v172 quad_perm:[1,1,1,1] row_mask:0xf bank_mask:0xf
    v_and_b32_dpp v37, v48, v173 quad_perm:[1,1,1,1] row_mask:0xf bank_mask:0xf
    v_and_b32_dpp v38, v48, v174 quad_perm:[1,1,1,1] row_mask:0xf bank_mask:0xf
    v_and_b32_dpp v39, v48, v175 quad_perm:[1,1,1,1] row_mask:0xf bank_mask:0xf
    v_and_b32_dpp v40, v48, v172 quad_perm:[2,2,2,2] row_mask:0xf bank_mask:0xf
    v_and_b32_dpp v41, v48, v173 quad_perm:[2,2,2,2] row_mask:0xf bank_mask:0xf
    v_and_b32_dpp v42, v48, v174 quad_perm:[2,2,2,2] row_mask:0xf bank_mask:0xf
    v_and_b32_dpp v43, v48, v175 quad_perm:[2,2,2,2] row_mask:0xf bank_mask:0xf
    v_and_b32_dpp v44, v48, v172 quad_perm:[3,3,3,3] row_mask:0xf bank_mask:0xf
    v_and_b32_dpp v45, v48, v173 quad_perm:[3,3,3,3] row_mask:0xf bank_mask:0xf
    v_and_b32_dpp v46, v48, v174 quad_perm:[3,3,3,3] row_mask:0xf bank_mask:0xf
    v_and_b32_dpp v47, v48, v175 quad_perm:[3,3,3,3] row_mask:0xf bank_mask:0xf
    s_nop 1
    v_mfma_f32_16x16x32_bf16 v[60:63], v[32:35], v[144:147], 0
    v_mfma_f32_16x16x32_bf16 v[60:63], v[36:39], v[148:151], v[60:63]
    v_mfma_f32_16x16x32_bf16 v[60:63], v[40:43], v[152:155], v[60:63]
    v_mfma_f32_16x16x32_bf16 v[60:63], v[44:47], v[156:159], v[60:63]
    s_lshl_b32 s6, s14, 11
    s_lshl_b32 s7, s3, 9
    s_add_u32 s6, s6, s7
    s_add_u32 s6, s6, 524288
    v_add_u32 v9, s6, v4
    v_and_b32 v11, 1, v0
    v_lshrrev_b32 v12, 1, v0
    v_lshl_add_u32 v11, v11, 4, v12
    v_lshlrev_b32 v11, 2, v11
    v_bfi_b32 v60, s62, v14, v60
    ds_bpermute_b32 v60, v11, v60
    v_bfi_b32 v61, s62, v14, v61
    ds_bpermute_b32 v61, v11, v61
    v_bfi_b32 v62, s62, v14, v62
    ds_bpermute_b32 v62, v11, v62
    v_bfi_b32 v63, s62, v14, v63
    ds_bpermute_b32 v63, v11, v63
    s_mov_b32 exec_hi, 0
    s_waitcnt lgkmcnt(0)
    buffer_store_dwordx4 v[60:63], v9, s[52:55], 0 offen sc1
    s_mov_b64 exec, -1
P_nomlp:
    s_waitcnt vmcnt(1)
    s_cmp_lt_u32 s14, 86
    s_cbranch_scc1 P_cleared2
    s_branch P_cleared1
P_cleared:
    buffer_load_dword v19, v118, s[52:55], 0 offen sc1
    s_add_u32 s64, s64, 1
    s_cmp_gt_u32 s64, 1048576
    s_cbranch_scc1 L_end
P_cleared1:
    s_waitcnt vmcnt(0)
P_cleared2:
    v_xor_b32 v19, s59, v19
    v_and_b32 v19, 0xffff, v19
    v_cmp_ne_u32 vcc, 0, v19
    s_cbranch_vccnz P_cleared
    s_barrier
    ds_read_b64_tr_b16 v[64:65], v100 offset:0
    ds_read_b64_tr_b16 v[66:67], v100 offset:4224
    ds_read_b64_tr_b16 v[68:69], v100 offset:32
    ds_read_b64_tr_b16 v[70:71], v100 offset:4256
    ds_read_b64_tr_b16 v[72:73], v100 offset:8448
    ds_read_b64_tr_b16 v[74:75], v100 offset:12672
    ds_read_b64_tr_b16 v[76:77], v100 offset:8480
    ds_read_b64_tr_b16 v[78:79], v100 offset:12704
    ds_read_b64_tr_b16 v[80:81], v100 offset:16896
    ds_read_b64_tr_b16 v[82:83], v100 offset:21120
    ds_read_b64_tr_b16 v[84:85], v100 offset:16928
    ds_read_b64_tr_b16 v[86:87], v100 offset:21152
    ds_read_b64_tr_b16 v[88:89], v100 offset:25344
    ds_read_b64_tr_b16 v[90:91], v100 offset:29568
    ds_read_b64_tr_b16 v[92:93], v100 offset:25376
    ds_read_b64_tr_b16 v[94:95], v100 offset:29600
P_pollcx:
    buffer_load_dwordx4 v[128:131], v117, s[52:55], s65 offen offset:0 sc1
    buffer_load_dwordx4 v[132:135], v117, s[52:55], s65 offen offset:1024 sc1
    buffer_load_dwordx4 v[136:139], v117, s[52:55], s65 offen offset:2048 sc1
    buffer_load_dwordx4 v[140:143], v117, s[52:55], s65 offen offset:3072 sc1
    s_add_u32 s64, s64, 1
    s_cmp_gt_u32 s64, 1048576
    s_cbranch_scc1 L_end
    s_add_u32 s20, s20, 1
    s_and_b32 s6, s20, 1
    s_cmp_gt_u32 s20, 40
    s_cselect_b32 s6, s6, 0
    s_lshl_b32 s65, s6, 20
    s_waitcnt lgkmcnt(0)
    s_waitcnt vmcnt(3)
    v_and_b32 v21, 1, v128
    v_cmp_ne_u32 vcc, 1, v21
    s_cbranch_vccnz P_pollcx
    v_mfma_f32_16x16x32_bf16 v[32:35], v[128:131], v[64:67], 0
    v_mfma_f32_16x16x32_bf16 v[36:39], v[128:131], v[68:71], 0
    s_waitcnt vmcnt(2)
    v_mfma_f32_16x16x32_bf16 v[32:35], v[132:135], v[72:75], v[32:35]
    v_mfma_f32_16x16x32_bf16 v[36:39], v[132:135], v[76:79], v[36:39]
    s_waitcnt vmcnt(1)
    v_mfma_f32_16x16x32_bf16 v[32:35], v[136:139], v[80:83], v[32:35]
    v_mfma_f32_16x16x32_bf16 v[36:39], v[136:139], v[84:87], v[36:39]
    s_waitcnt vmcnt(0)
    v_mfma_f32_16x16x32_bf16 v[32:35], v[140:143], v[88:91], v[32:35]
    v_mfma_f32_16x16x32_bf16 v[36:39], v[140:143], v[92:95], v[36:39]
    v_bitop3_b32 v21, v132, v136, v140 bitop3:0x80
    v_and_b32 v21, 1, v21
    v_cmp_ne_u32 vcc, 1, v21
    s_cbranch_vccnz P_pollcx
    s_nop 2
    v_add_f32 v32, v32, v33
    v_add_f32 v36, v36, v37
    v_add_f32 v34, v34, v35
    v_add_f32 v38, v38, v39
    v_add_f32 v32, v32, v34
    v_add_f32 v36, v36, v38
    s_nop 1
    v_permlane32_swap_b32 v32, v36
    v_add_f32 v32, v32, v36
    v_mov_b32 v33, v32
    s_nop 1
    v_permlane16_swap_b32 v33, v32
    v_add_f32 v24, v32, v33
    s_nop 1
    v_mov_b32_dpp v25, v24 row_shl:4 row_mask:0xf bank_mask:0xf
    v_mov_b32_dpp v26, v24 row_shl:8 row_mask:0xf bank_mask:0xf
    v_mov_b32_dpp v27, v24 row_shl:12 row_mask:0xf bank_mask:0xf
    v_bfi_b32 v24, s62, v14, v24
    v_bfi_b32 v26, s62, v14, v26
    s_mov_b32 exec_lo, 15
    s_mov_b32 exec_hi, 15
    buffer_store_dwordx4 v[24:27], v15, s[52:55], 0 offen sc1
L_end:
    s_endpgm
.p2align 12
A_setup:
    s_lshr_b32 s6, s5, 1
    s_lshl_b32 s12, s4, 3
    s_add_u32 s12, s12, s6
    s_and_b32 s13, s5, 1
    s_lshl_b32 s6, s12, 2
    s_add_u32 s6, s6, s3
    s_lshl_b32 s68, s6, 15
    s_lshl_b32 s6, s13, 14
    s_add_u32 s68, s68, s6
    s_mul_i32 s69, s3, 33792
    s_mov_b32 s36, s10
    s_mov_b32 s37, s11
    s_mov_b32 s38, 8388608
    s_mov_b32 s39, 0x20000
    s_mov_b32 m0, s69
    s_movk_i32 s20, 1056
    s_movk_i32 s21, 0x400
    v_lshlrev_b32 v8, 2, v3
    v_add_u32 v8, 156160, v8
    v_mov_b32 v20, 0xff800000
    ds_write_b32 v8, v20
    v_mul_u32_u24 v5, 1056, v3
    v_lshl_add_u32 v5, v2, 4, v5
    v_add_u32 v180, 135168, v5
    v_add_u32 v5, s69, v5
    v_lshrrev_b32 v9, 2, v0
    v_mul_u32_u24 v9, 1056, v9
    v_lshl_add_u32 v9, v7, 3, v9
    s_lshl_b32 s6, s3, 8
    v_add_u32 v9, s6, v9
    s_add_u32 s6, s3, 0
    s_and_b32 s6, s6, 3
    s_mul_i32 s7, s6, 33792
    v_add_u32 v176, s7, v9
    s_lshl_b32 s6, s6, 10
    s_add_u32 s6, s6, 152064
    v_add_u32 v12, s6, v4
    s_add_u32 s6, s3, 1
    s_and_b32 s6, s6, 3
    s_mul_i32 s7, s6, 33792
    v_add_u32 v177, s7, v9
    s_lshl_b32 s6, s6, 10
    s_add_u32 s6, s6, 152064
    v_add_u32 v13, s6, v4
    s_add_u32 s6, s3, 2
    s_and_b32 s6, s6, 3
    s_mul_i32 s7, s6, 33792
    v_add_u32 v178, s7, v9
    s_lshl_b32 s6, s6, 10
    s_add_u32 s6, s6, 152064
    v_add_u32 v14, s6, v4
    s_add_u32 s6, s3, 3
    s_and_b32 s6, s6, 3
    s_mul_i32 s7, s6, 33792
    v_add_u32 v179, s7, v9
    s_lshl_b32 s6, s6, 10
    s_add_u32 s6, s6, 152064
    v_add_u32 v15, s6, v4
    s_lshl_b32 s6, s13, 15
    s_lshl_b32 s7, s3, 13
    s_add_u32 s6, s6, s7
    s_add_u32 s6, s6, 131072
    v_add_u32 v181, s6, v4
    v_add_u32 v182, 0x1000, v181
    s_mul_i32 s6, s3, 4224
    s_add_u32 s6, s6, 135168
    v_lshl_add_u32 v11, v0, 3, s6
    s_waitcnt lgkmcnt(0)
    s_add_u32 s56, s56, 1
    s_and_b32 s57, s56, 0xfff
    s_and_b32 s59, s56, 0x1fff
    s_or_b32 s59, s59, 0x4000
    s_lshl_b32 s58, s59, 16
    s_movk_i32 s62, 0xfff
    s_mov_b32 s63, 0x07060302
    s_mov_b32 s100, 0x05040100
    s_lshl_b32 s6, s3, 9
    s_add_u32 s6, s6, 152064
    v_add_u32 v56, s6, v4
    v_add_u32 v57, 152064, v4
    s_waitcnt vmcnt(6)
    v_lshlrev_b32 v24, 16, v120
    v_and_b32 v25, 0xffff0000, v120
    v_lshlrev_b32 v26, 16, v121
    v_and_b32 v27, 0xffff0000, v121
    v_lshlrev_b32 v28, 16, v122
    v_and_b32 v29, 0xffff0000, v122
    v_lshlrev_b32 v30, 16, v123
    v_and_b32 v31, 0xffff0000, v123
    v_add_f32 v124, v24, v25
    v_add_f32 v48, v26, v27
    v_add_f32 v49, v28, v29
    v_add_f32 v125, v30, v31
    v_add_f32 v124, v124, v48
    v_add_f32 v49, v49, v125
    v_add_f32 v124, v124, v49
    s_nop 1
    v_add_f32_dpp v124, v124, v124 quad_perm:[1,0,3,2] row_mask:0xf bank_mask:0xf
    s_nop 1
    v_add_f32_dpp v124, v124, v124 quad_perm:[2,3,0,1] row_mask:0xf bank_mask:0xf
    s_nop 1
    v_add_f32_dpp v124, v124, v124 row_ror:4 row_mask:0xf bank_mask:0xf
    s_nop 1
    v_add_f32_dpp v124, v124, v124 row_ror:8 row_mask:0xf bank_mask:0xf
    v_mov_b32 v48, v124
    s_nop 1
    v_permlane16_swap_b32 v48, v124
    v_add_f32 v124, v124, v48
    v_mov_b32 v48, v124
    s_nop 1
    v_permlane32_swap_b32 v48, v124
    v_add_f32 v124, v124, v48
    v_mul_f32 v124, 0x3b000000, v124
    v_sub_f32 v48, v24, v124
    v_mul_f32 v125, v48, v48
    v_sub_f32 v48, v25, v124
    v_fmac_f32 v125, v48, v48
    v_sub_f32 v48, v26, v124
    v_fmac_f32 v125, v48, v48
    v_sub_f32 v48, v27, v124
    v_fmac_f32 v125, v48, v48
    v_sub_f32 v48, v28, v124
    v_fmac_f32 v125, v48, v48
    v_sub_f32 v48, v29, v124
    v_fmac_f32 v125, v48, v48
    v_sub_f32 v48, v30, v124
    v_fmac_f32 v125, v48, v48
    v_sub_f32 v48, v31, v124
    v_fmac_f32 v125, v48, v48
    s_nop 1
    v_add_f32_dpp v125, v125, v125 quad_perm:[1,0,3,2] row_mask:0xf bank_mask:0xf
    s_nop 1
    v_add_f32_dpp v125, v125, v125 quad_perm:[2,3,0,1] row_mask:0xf bank_mask:0xf
    s_nop 1
    v_add_f32_dpp v125, v125, v125 row_ror:4 row_mask:0xf bank_mask:0xf
    s_nop 1
    v_add_f32_dpp v125, v125, v125 row_ror:8 row_mask:0xf bank_mask:0xf
    v_mov_b32 v48, v125
    s_nop 1
    v_permlane16_swap_b32 v48, v125
    v_add_f32 v125, v125, v48
    v_mov_b32 v48, v125
    s_nop 1
    v_permlane32_swap_b32 v48, v125
    v_add_f32 v125, v125, v48
    v_mul_f32 v125, 0x3b000000, v125
    v_cvt_pk_bf16_f32 v124, 0, v124
    v_cvt_pk_bf16_f32 v125, 0, v125
    v_add_f32 v125, 0x3727c5ac, v125
    v_cvt_pk_bf16_f32 v125, 0, v125
    v_sqrt_f32 v125, v125
    s_nop 0
    v_cvt_pk_bf16_f32 v125, 0, v125
    v_rcp_f32 v125, v125
    s_nop 0
    s_waitcnt vmcnt(5)
    v_lshlrev_b32 v24, 16, v126
    v_and_b32 v25, 0xffff0000, v126
    v_lshlrev_b32 v26, 16, v127
    v_and_b32 v27, 0xffff0000, v127
    v_sub_f32 v24, v24, v124
    v_cvt_pk_bf16_f32 v24, 0, v24
    v_mul_f32 v24, v24, v125
    v_cvt_pk_bf16_f32 v24, v24, v24
    v_sub_f32 v25, v25, v124
    v_cvt_pk_bf16_f32 v25, 0, v25
    v_mul_f32 v25, v25, v125
    v_cvt_pk_bf16_f32 v25, v25, v25
    v_sub_f32 v26, v26, v124
    v_cvt_pk_bf16_f32 v26, 0, v26
    v_mul_f32 v26, v26, v125
    v_cvt_pk_bf16_f32 v26, v26, v26
    v_sub_f32 v27, v27, v124
    v_cvt_pk_bf16_f32 v27, 0, v27
    v_mul_f32 v27, v27, v125
    v_cvt_pk_bf16_f32 v27, v27, v27
    v_and_b32 v48, v24, v172
    v_and_b32 v49, v24, v173
    v_and_b32 v50, v24, v174
    v_and_b32 v51, v24, v175
    s_waitcnt vmcnt(4)
    s_nop 0
    v_mfma_f32_16x16x32_bf16 v[108:111], v[48:51], v[32:35], 0
    v_and_b32 v52, v25, v172
    v_and_b32 v53, v25, v173
    v_and_b32 v54, v25, v174
    v_and_b32 v55, v25, v175
    s_waitcnt vmcnt(3)
    s_nop 0
    v_mfma_f32_16x16x32_bf16 v[108:111], v[52:55], v[36:39], v[108:111]
    buffer_load_dwordx4 v4, s[36:39], s68 offen  lds
    s_add_u32 m0, m0, s20
    s_add_u32 s68, s68, s21
    v_and_b32 v48, v26, v172
    v_and_b32 v49, v26, v173
    v_and_b32 v50, v26, v174
    v_and_b32 v51, v26, v175
    s_waitcnt vmcnt(3)
    s_nop 0
    v_mfma_f32_16x16x32_bf16 v[108:111], v[48:51], v[40:43], v[108:111]
    buffer_load_dwordx4 v4, s[36:39], s68 offen  lds
    s_add_u32 m0, m0, s20
    s_add_u32 s68, s68, s21
    v_and_b32 v52, v27, v172
    v_and_b32 v53, v27, v173
    v_and_b32 v54, v27, v174
    v_and_b32 v55, v27, v175
    s_waitcnt vmcnt(3)
    s_nop 0
    v_mfma_f32_16x16x32_bf16 v[108:111], v[52:55], v[44:47], v[108:111]
    buffer_load_dwordx4 v4, s[36:39], s68 offen  lds
    s_add_u32 m0, m0, s20
    s_add_u32 s68, s68, s21
    s_mov_b32 exec_hi, 0
    s_nop 5
    ds_write_b128 v56, v[108:111]
    s_mov_b64 exec, -1
    s_waitcnt lgkmcnt(0)
    s_barrier
    s_cmp_lg_u32 s3, 0
    s_cbranch_scc1 A_nopub
    s_mov_b32 exec_hi, 0
    ds_read_b128 v[32:35], v57 offset:0
    ds_read_b128 v[36:39], v57 offset:512
    ds_read_b128 v[40:43], v57 offset:1024
    ds_read_b128 v[44:47], v57 offset:1536
    v_mov_b32 v28, s57
    s_waitcnt lgkmcnt(2)
    v_add_f32 v32, v32, v36
    v_add_f32 v33, v33, v37
    v_add_f32 v34, v34, v38
    v_add_f32 v35, v35, v39
    s_waitcnt lgkmcnt(0)
    v_add_f32 v40, v40, v44
    v_add_f32 v41, v41, v45
    v_add_f32 v42, v42, v46
    v_add_f32 v43, v43, v47
    v_add_f32 v100, v32, v40
    v_add_f32 v101, v33, v41
    v_add_f32 v102, v34, v42
    v_add_f32 v103, v35, v43
    s_movk_i32 s6, 0xff
    v_bfi_b32 v100, s6, v28, v100
    v_bfi_b32 v101, s6, v28, v101
    v_bfi_b32 v102, s6, v28, v102
    v_bfi_b32 v103, s6, v28, v103
    buffer_store_dwordx4 v[100:103], v105, s[52:55], 0 offen
    buffer_store_dwordx4 v[100:103], v105, s[52:55], s101 offen sc1
    s_mov_b64 exec, -1
A_nopub:
    s_barrier
    s_mov_b32 s6, 8
A_rows_1:
    buffer_load_dwordx4 v4, s[36:39], s68 offen  lds
    s_add_u32 m0, m0, s20
    s_add_u32 s68, s68, s21
    s_sub_u32 s6, s6, 1
    s_cmp_lg_u32 s6, 0
    s_cbranch_scc1 A_rows_1
    s_lshl_b32 s6, s12, 9
    s_lshl_b32 s7, s13, 8
    s_add_u32 s6, s6, s7
    s_add_u32 s6, s6, 196608
    v_add_u32 v16, s6, v4
    s_lshl_b32 s6, s12, 15
    s_lshl_b32 s7, s13, 14
    s_add_u32 s6, s6, s7
    s_lshl_b32 s7, s3, 10
    s_add_u32 s6, s6, s7
    s_add_u32 s6, s6, 2097152
    v_lshlrev_b32 v17, 12, v1
    v_lshl_add_u32 v17, v2, 6, v17
    v_lshl_add_u32 v17, v7, 4, v17
    v_add_u32 v17, s6, v17
    s_lshl_b32 s6, s3, 13
    s_lshl_b32 s7, s4, 6
    s_add_u32 s6, s6, s7
    s_add_u32 s6, s6, 196608
    v_lshrrev_b32 v9, 2, v0
    v_lshlrev_b32 v239, 9, v9
    v_lshl_add_u32 v239, v7, 4, v239
    v_add_u32 v239, s6, v239
    s_lshl_b32 s6, s33, 18
    s_lshl_b32 s7, s3, 3
    s_add_u32 s7, s7, s4
    s_lshl_b32 s7, s7, 8
    s_add_u32 s6, s6, s7
    v_lshlrev_b32 v183, 4, v3
    v_lshl_add_u32 v183, v10, 17, v183
    v_lshrrev_b32 v9, 1, v2
    v_lshl_add_u32 v183, v9, 15, v183
    v_add_u32 v183, s6, v183
    s_mov_b32 s44, s16
    s_mov_b32 s45, s17
    s_mov_b32 s46, 4194304
    s_mov_b32 s47, 0x20000
    s_mov_b32 s14, 8192
    s_mov_b32 s15, 16384
    s_mov_b32 s16, 24576
    v_mov_b32 v20, 0x3f803f80
    v_mov_b32 v21, v20
    v_mov_b32 v22, v20
    v_mov_b32 v23, v20
    v_mov_b32 v58, s56
    v_mov_b32 v59, s56
    s_bfe_u32 s6, s56, 0x10000
    s_bfe_u32 s7, s56, 0x10001
    s_lshl_b32 s7, s7, 16
    s_or_b32 s6, s6, s7
    v_mov_b32 v184, s6
    s_bfe_u32 s6, s56, 0x10002
    s_bfe_u32 s7, s56, 0x10003
    s_lshl_b32 s7, s7, 16
    s_or_b32 s6, s6, s7
    v_mov_b32 v185, s6
    s_bfe_u32 s6, s56, 0x10004
    s_bfe_u32 s7, s56, 0x10005
    s_lshl_b32 s7, s7, 16
    s_or_b32 s6, s6, s7
    v_mov_b32 v186, s6
    s_bfe_u32 s6, s56, 0x10006
    s_bfe_u32 s7, s56, 0x10007
    s_lshl_b32 s7, s7, 16
    s_or_b32 s6, s6, s7
    v_mov_b32 v187, s6
    s_mov_b32 s61, 0x00010001
    v_lshlrev_b32 v189, 4, v3
    v_add_u32 v189, 156416, v189
    s_lshl_b32 s6, s3, 2
    v_add_u32 v188, s6, v189
    s_branch A_core
.p2align 12
A_core:
    s_sub_u32 s68, s68, 11264
    s_xor_b32 s68, s68, 0x4000
    s_add_u32 s68, s68, 0
    s_mov_b32 s6, 11
A_rows_2:
    buffer_load_dwordx4 v4, s[36:39], s68 offen  lds
    s_add_u32 m0, m0, s20
    s_add_u32 s68, s68, s21
    s_sub_u32 s6, s6, 1
    s_cmp_lg_u32 s6, 0
    s_cbranch_scc1 A_rows_2
    s_waitcnt vmcnt(6)
    s_sub_u32 s68, s68, 11264
    s_xor_b32 s68, s68, 0x4000
    s_add_u32 s68, s68, 11264
    buffer_load_dwordx4 v4, s[36:39], s68 offen  lds
    s_add_u32 m0, m0, s20
    s_add_u32 s68, s68, s21
    ds_read_b128 a[0:3], v5 offset:0
    ds_read_b128 a[4:7], v5 offset:64
    buffer_load_dwordx4 v4, s[36:39], s68 offen  lds
    s_add_u32 m0, m0, s20
    s_add_u32 s68, s68, s21
    ds_read_b128 a[8:11], v5 offset:128
    ds_read_b128 a[12:15], v5 offset:192
    buffer_load_dwordx4 v4, s[36:39], s68 offen  lds
    s_add_u32 m0, m0, s20
    s_add_u32 s68, s68, s21
    ds_read_b128 a[16:19], v5 offset:256
    ds_read_b128 a[20:23], v5 offset:320
    buffer_load_dwordx4 v4, s[36:39], s68 offen  lds
    s_add_u32 m0, m0, s20
    s_add_u32 s68, s68, s21
    ds_read_b128 a[24:27], v5 offset:384
    ds_read_b128 a[28:31], v5 offset:448
    buffer_load_dwordx4 v4, s[36:39], s68 offen  lds
    s_add_u32 m0, m0, s20
    s_add_u32 s68, s68, s21
    ds_read_b128 a[32:35], v5 offset:512
    ds_read_b128 a[36:39], v5 offset:576
    s_sub_u32 s68, s68, 16384
    s_xor_b32 s68, s68, 0x4000
    s_add_u32 s68, s68, 11264
    buffer_load_dwordx4 v4, s[36:39], s68 offen  lds
    s_add_u32 m0, m0, s20
    s_add_u32 s68, s68, s21
    ds_read_b128 a[40:43], v5 offset:640
    ds_read_b128 a[44:47], v5 offset:704
    buffer_load_dwordx4 v4, s[36:39], s68 offen  lds
    s_add_u32 m0, m0, s20
    s_add_u32 s68, s68, s21
    ds_read_b128 a[48:51], v5 offset:768
    ds_read_b128 a[52:55], v5 offset:832
    buffer_load_dwordx4 v4, s[36:39], s68 offen  lds
    s_add_u32 m0, m0, s20
    s_add_u32 s68, s68, s21
    ds_read_b128 a[56:59], v5 offset:896
    ds_read_b128 a[60:63], v5 offset:960
    buffer_load_dwordx4 v4, s[36:39], s68 offen  lds
    s_add_u32 m0, m0, s20
    s_add_u32 s68, s68, s21
    buffer_load_dwordx4 v4, s[36:39], s68 offen  lds
    s_add_u32 m0, m0, s20
    s_add_u32 s68, s68, s21
    s_barrier
    buffer_load_dwordx4 v[112:115], v181, s[52:55], 0 offen offset:0 sc1
    ds_read_b64_tr_b16 a[128:129], v176 offset:0
    ds_read_b64_tr_b16 a[132:133], v176 offset:32
    ds_read_b64_tr_b16 a[136:137], v176 offset:64
    ds_read_b64_tr_b16 a[140:141], v176 offset:96
    buffer_load_dwordx4 v[116:119], v181, s[52:55], 0 offen offset:1024 sc1
    ds_read_b64_tr_b16 a[144:145], v176 offset:128
    ds_read_b64_tr_b16 a[148:149], v176 offset:160
    ds_read_b64_tr_b16 a[152:153], v176 offset:192
    ds_read_b64_tr_b16 a[156:157], v176 offset:224
    buffer_load_dwordx4 v[120:123], v181, s[52:55], 0 offen offset:2048 sc1
    ds_read_b64_tr_b16 a[160:161], v177 offset:0
    ds_read_b64_tr_b16 a[164:165], v177 offset:32
    ds_read_b64_tr_b16 a[168:169], v177 offset:64
    ds_read_b64_tr_b16 a[172:173], v177 offset:96
    buffer_load_dwordx4 v[124:127], v181, s[52:55], 0 offen offset:3072 sc1
    ds_read_b64_tr_b16 a[176:177], v177 offset:128
    ds_read_b64_tr_b16 a[180:181], v177 offset:160
    ds_read_b64_tr_b16 a[184:185], v177 offset:192
    ds_read_b64_tr_b16 a[188:189], v177 offset:224
    buffer_load_dwordx4 v[128:131], v182, s[52:55], 0 offen offset:0 sc1
    ds_read_b64_tr_b16 a[192:193], v178 offset:0
    ds_read_b64_tr_b16 a[196:197], v178 offset:32
    ds_read_b64_tr_b16 a[200:201], v178 offset:64
    ds_read_b64_tr_b16 a[204:205], v178 offset:96
    buffer_load_dwordx4 v[132:135], v182, s[52:55], 0 offen offset:1024 sc1
    ds_read_b64_tr_b16 a[208:209], v178 offset:128
    ds_read_b64_tr_b16 a[212:213], v178 offset:160
    ds_read_b64_tr_b16 a[216:217], v178 offset:192
    ds_read_b64_tr_b16 a[220:221], v178 offset:224
    buffer_load_dwordx4 v[136:139], v182, s[52:55], 0 offen offset:2048 sc1
    ds_read_b64_tr_b16 a[224:225], v179 offset:0
    ds_read_b64_tr_b16 a[228:229], v179 offset:32
    ds_read_b64_tr_b16 a[232:233], v179 offset:64
    ds_read_b64_tr_b16 a[236:237], v179 offset:96
    buffer_load_dwordx4 v[140:143], v182, s[52:55], 0 offen offset:3072 sc1
    ds_read_b64_tr_b16 a[240:241], v179 offset:128
    ds_read_b64_tr_b16 a[244:245], v179 offset:160
    ds_read_b64_tr_b16 a[248:249], v179 offset:192
    ds_read_b64_tr_b16 a[252:253], v179 offset:224
    s_waitcnt vmcnt(8)
    ds_read_b128 a[64:67], v5 offset:16896
    ds_read_b128 a[68:71], v5 offset:16960
    ds_read_b128 a[72:75], v5 offset:17024
    ds_read_b128 a[76:79], v5 offset:17088
    ds_read_b128 a[80:83], v5 offset:17152
    ds_read_b128 a[84:87], v5 offset:17216
    ds_read_b128 a[88:91], v5 offset:17280
    ds_read_b128 a[92:95], v5 offset:17344
    ds_read_b128 a[96:99], v5 offset:17408
    ds_read_b128 a[100:103], v5 offset:17472
    ds_read_b128 a[104:107], v5 offset:17536
    ds_read_b128 a[108:111], v5 offset:17600
    ds_read_b128 a[112:115], v5 offset:17664
    ds_read_b128 a[116:119], v5 offset:17728
    ds_read_b128 a[120:123], v5 offset:17792
    ds_read_b128 a[124:127], v5 offset:17856
A_pollb:
    v_mov_b32 v19, 0
    s_waitcnt vmcnt(7)
    v_perm_b32 v32, v113, v112, s63
    v_perm_b32 v33, v115, v114, s63
    ds_write_b64 v11, v[32:33] offset:0
    v_bitop3_b32 v19, v19, v112, s59 bitop3:0xf6
    v_bitop3_b32 v19, v19, v115, s59 bitop3:0xf6
    s_waitcnt vmcnt(6)
    v_perm_b32 v34, v117, v116, s63
    v_perm_b32 v35, v119, v118, s63
    ds_write_b64 v11, v[34:35] offset:512
    v_bitop3_b32 v19, v19, v116, s59 bitop3:0xf6
    v_bitop3_b32 v19, v19, v119, s59 bitop3:0xf6
    s_waitcnt vmcnt(5)
    v_perm_b32 v36, v121, v120, s63
    v_perm_b32 v37, v123, v122, s63
    ds_write_b64 v11, v[36:37] offset:1056
    v_bitop3_b32 v19, v19, v120, s59 bitop3:0xf6
    v_bitop3_b32 v19, v19, v123, s59 bitop3:0xf6
    s_waitcnt vmcnt(4)
    v_perm_b32 v38, v125, v124, s63
    v_perm_b32 v39, v127, v126, s63
    ds_write_b64 v11, v[38:39] offset:1568
    v_bitop3_b32 v19, v19, v124, s59 bitop3:0xf6
    v_bitop3_b32 v19, v19, v127, s59 bitop3:0xf6
    s_waitcnt vmcnt(3)
    v_perm_b32 v40, v129, v128, s63
    v_perm_b32 v41, v131, v130, s63
    ds_write_b64 v11, v[40:41] offset:2112
    v_bitop3_b32 v19, v19, v128, s59 bitop3:0xf6
    v_bitop3_b32 v19, v19, v131, s59 bitop3:0xf6
    s_waitcnt vmcnt(2)
    v_perm_b32 v42, v133, v132, s63
    v_perm_b32 v43, v135, v134, s63
    ds_write_b64 v11, v[42:43] offset:2624
    v_bitop3_b32 v19, v19, v132, s59 bitop3:0xf6
    v_bitop3_b32 v19, v19, v135, s59 bitop3:0xf6
    s_waitcnt vmcnt(1)
    v_perm_b32 v44, v137, v136, s63
    v_perm_b32 v45, v139, v138, s63
    ds_write_b64 v11, v[44:45] offset:3168
    v_bitop3_b32 v19, v19, v136, s59 bitop3:0xf6
    v_bitop3_b32 v19, v19, v139, s59 bitop3:0xf6
    s_waitcnt vmcnt(0)
    v_perm_b32 v46, v141, v140, s63
    v_perm_b32 v47, v143, v142, s63
    ds_write_b64 v11, v[46:47] offset:3680
    v_bitop3_b32 v19, v19, v140, s59 bitop3:0xf6
    v_bitop3_b32 v19, v19, v143, s59 bitop3:0xf6
    v_and_b32 v19, 0xffff, v19
    v_cmp_ne_u32 vcc, 0, v19
    s_cbranch_vccz A_gotq
    buffer_load_dwordx4 v[112:115], v181, s[52:55], 0 offen offset:0 sc1
    buffer_load_dwordx4 v[116:119], v181, s[52:55], 0 offen offset:1024 sc1
    buffer_load_dwordx4 v[120:123], v181, s[52:55], 0 offen offset:2048 sc1
    buffer_load_dwordx4 v[124:127], v181, s[52:55], 0 offen offset:3072 sc1
    buffer_load_dwordx4 v[128:131], v182, s[52:55], 0 offen offset:0 sc1
    buffer_load_dwordx4 v[132:135], v182, s[52:55], 0 offen offset:1024 sc1
    buffer_load_dwordx4 v[136:139], v182, s[52:55], 0 offen offset:2048 sc1
    buffer_load_dwordx4 v[140:143], v182, s[52:55], 0 offen offset:3072 sc1
    s_add_u32 s64, s64, 1
    s_cmp_gt_u32 s64, 1048576
    s_cbranch_scc1 L_end
    s_branch A_pollb
A_gotq:
    s_waitcnt lgkmcnt(0)
    s_barrier
    ds_read_b128 v[64:67], v180 offset:0
    ds_read_b128 v[68:71], v180 offset:64
    ds_read_b128 v[72:75], v180 offset:128
    ds_read_b128 v[76:79], v180 offset:192
    s_mov_b32 s21, 0x3fb8aa3b
    buffer_load_dwordx4 v[192:195], v183, s[44:47], 0 offen nt
    s_waitcnt lgkmcnt(3)
    v_mfma_f32_16x16x32_bf16 v[24:27], a[0:3], v[64:67], 0
    ds_read_b128 v[80:83], v180 offset:256
    v_mfma_f32_16x16x32_bf16 v[28:31], a[64:67], v[64:67], 0
    buffer_load_dwordx4 v[196:199], v183, s[44:47], s14 offen nt
    s_waitcnt lgkmcnt(3)
    v_mfma_f32_16x16x32_bf16 v[24:27], a[4:7], v[68:71], v[24:27]
    ds_read_b128 v[84:87], v180 offset:320
    ds_read_b64_tr_b16 a[130:131], v176 offset:16896
    v_mfma_f32_16x16x32_bf16 v[28:31], a[68:71], v[68:71], v[28:31]
    ds_read_b64_tr_b16 a[134:135], v176 offset:16928
    s_waitcnt lgkmcnt(5)
    v_mfma_f32_16x16x32_bf16 v[24:27], a[8:11], v[72:75], v[24:27]
    ds_read_b128 v[88:91], v180 offset:384
    ds_read_b64_tr_b16 a[138:139], v176 offset:16960
    v_mfma_f32_16x16x32_bf16 v[28:31], a[72:75], v[72:75], v[28:31]
    ds_read_b64_tr_b16 a[142:143], v176 offset:16992
    buffer_load_dwordx4 v[200:203], v183, s[44:47], s15 offen nt
    s_waitcnt lgkmcnt(7)
    v_mfma_f32_16x16x32_bf16 v[24:27], a[12:15], v[76:79], v[24:27]
    ds_read_b128 v[92:95], v180 offset:448
    ds_read_b64_tr_b16 a[146:147], v176 offset:17024
    v_mfma_f32_16x16x32_bf16 v[28:31], a[76:79], v[76:79], v[28:31]
    ds_read_b64_tr_b16 a[150:151], v176 offset:17056
    s_waitcnt lgkmcnt(9)
    v_mfma_f32_16x16x32_bf16 v[24:27], a[16:19], v[80:83], v[24:27]
    ds_read_b128 v[96:99], v180 offset:512
    ds_read_b64_tr_b16 a[154:155], v176 offset:17088
    v_mfma_f32_16x16x32_bf16 v[28:31], a[80:83], v[80:83], v[28:31]
    ds_read_b64_tr_b16 a[158:159], v176 offset:17120
    buffer_load_dwordx4 v[204:207], v183, s[44:47], s16 offen nt
    s_waitcnt lgkmcnt(11)
    v_mfma_f32_16x16x32_bf16 v[24:27], a[20:23], v[84:87], v[24:27]
    ds_read_b128 v[100:103], v180 offset:576
    ds_read_b64_tr_b16 a[162:163], v177 offset:16896
    v_mfma_f32_16x16x32_bf16 v[28:31], a[84:87], v[84:87], v[28:31]
    ds_read_b64_tr_b16 a[166:167], v177 offset:16928
    s_waitcnt lgkmcnt(11)
    v_mfma_f32_16x16x32_bf16 v[24:27], a[24:27], v[88:91], v[24:27]
    ds_read_b128 v[104:107], v180 offset:640
    ds_read_b64_tr_b16 a[170:171], v177 offset:16960
    v_mfma_f32_16x16x32_bf16 v[28:31], a[88:91], v[88:91], v[28:31]
    ds_read_b64_tr_b16 a[174:175], v177 offset:16992
    s_waitcnt lgkmcnt(11)
    v_mfma_f32_16x16x32_bf16 v[24:27], a[28:31], v[92:95], v[24:27]
    ds_read_b128 v[108:111], v180 offset:704
    ds_read_b64_tr_b16 a[178:179], v177 offset:17024
    v_mfma_f32_16x16x32_bf16 v[28:31], a[92:95], v[92:95], v[28:31]
    ds_read_b64_tr_b16 a[182:183], v177 offset:17056
    s_waitcnt lgkmcnt(11)
    v_mfma_f32_16x16x32_bf16 v[24:27], a[32:35], v[96:99], v[24:27]
    ds_read_b128 v[112:115], v180 offset:768
    ds_read_b64_tr_b16 a[186:187], v177 offset:17088
    v_mfma_f32_16x16x32_bf16 v[28:31], a[96:99], v[96:99], v[28:31]
    ds_read_b64_tr_b16 a[190:191], v177 offset:17120
    s_waitcnt lgkmcnt(11)
    v_mfma_f32_16x16x32_bf16 v[24:27], a[36:39], v[100:103], v[24:27]
    ds_read_b128 v[116:119], v180 offset:832
    ds_read_b64_tr_b16 a[194:195], v178 offset:16896
    v_mfma_f32_16x16x32_bf16 v[28:31], a[100:103], v[100:103], v[28:31]
    ds_read_b64_tr_b16 a[198:199], v178 offset:16928
    s_waitcnt lgkmcnt(11)
    v_mfma_f32_16x16x32_bf16 v[24:27], a[40:43], v[104:107], v[24:27]
    ds_read_b128 v[120:123], v180 offset:896
    ds_read_b64_tr_b16 a[202:203], v178 offset:16960
    v_mfma_f32_16x16x32_bf16 v[28:31], a[104:107], v[104:107], v[28:31]
    ds_read_b64_tr_b16 a[206:207], v178 offset:16992
    s_waitcnt lgkmcnt(11)
    v_mfma_f32_16x16x32_bf16 v[24:27], a[44:47], v[108:111], v[24:27]
    ds_read_b128 v[124:127], v180 offset:960
    ds_read_b64_tr_b16 a[210:211], v178 offset:17024
    v_mfma_f32_16x16x32_bf16 v[28:31], a[108:111], v[108:111], v[28:31]
    ds_read_b64_tr_b16 a[214:215], v178 offset:17056
    s_waitcnt lgkmcnt(11)
    v_mfma_f32_16x16x32_bf16 v[24:27], a[48:51], v[112:115], v[24:27]
    ds_read_b64_tr_b16 a[218:219], v178 offset:17088
    ds_read_b64_tr_b16 a[222:223], v178 offset:17120
    v_mfma_f32_16x16x32_bf16 v[28:31], a[112:115], v[112:115], v[28:31]
    ds_read_b64_tr_b16 a[226:227], v179 offset:16896
    s_waitcnt lgkmcnt(11)
    v_mfma_f32_16x16x32_bf16 v[24:27], a[52:55], v[116:119], v[24:27]
    ds_read_b64_tr_b16 a[230:231], v179 offset:16928
    ds_read_b64_tr_b16 a[234:235], v179 offset:16960
    v_mfma_f32_16x16x32_bf16 v[28:31], a[116:119], v[116:119], v[28:31]
    ds_read_b64_tr_b16 a[238:239], v179 offset:16992
    s_waitcnt lgkmcnt(11)
    v_mfma_f32_16x16x32_bf16 v[24:27], a[56:59], v[120:123], v[24:27]
    ds_read_b64_tr_b16 a[242:243], v179 offset:17024
    ds_read_b64_tr_b16 a[246:247], v179 offset:17056
    v_mfma_f32_16x16x32_bf16 v[28:31], a[120:123], v[120:123], v[28:31]
    ds_read_b64_tr_b16 a[250:251], v179 offset:17088
    s_waitcnt lgkmcnt(11)
    v_mfma_f32_16x16x32_bf16 v[24:27], a[60:63], v[124:127], v[24:27]
    ds_read_b64_tr_b16 a[254:255], v179 offset:17120
    v_mfma_f32_16x16x32_bf16 v[28:31], a[124:127], v[124:127], v[28:31]
    s_nop 6
    v_max3_f32 v32, v24, v25, v26
    v_max3_f32 v32, v32, v27, v28
    v_max3_f32 v32, v32, v29, v30
    v_max_f32 v32, v32, v31
    ds_max_f32 v8, v32
    v_cvt_pk_bf16_f32 v24, 0, v24
    v_mul_f32 v24, 0x3db504f3, v24
    v_cvt_pk_bf16_f32 v24, 0, v24
    v_cvt_pk_bf16_f32 v25, 0, v25
    v_mul_f32 v25, 0x3db504f3, v25
    v_cvt_pk_bf16_f32 v25, 0, v25
    v_cvt_pk_bf16_f32 v26, 0, v26
    v_mul_f32 v26, 0x3db504f3, v26
    v_cvt_pk_bf16_f32 v26, 0, v26
    v_cvt_pk_bf16_f32 v27, 0, v27
    v_mul_f32 v27, 0x3db504f3, v27
    v_cvt_pk_bf16_f32 v27, 0, v27
    s_waitcnt lgkmcnt(0)
    s_barrier
    ds_read_b32 v56, v8
    v_cvt_pk_bf16_f32 v28, 0, v28
    v_mul_f32 v28, 0x3db504f3, v28
    v_cvt_pk_bf16_f32 v28, 0, v28
    v_cvt_pk_bf16_f32 v29, 0, v29
    v_mul_f32 v29, 0x3db504f3, v29
    v_cvt_pk_bf16_f32 v29, 0, v29
    v_cvt_pk_bf16_f32 v30, 0, v30
    v_mul_f32 v30, 0x3db504f3, v30
    v_cvt_pk_bf16_f32 v30, 0, v30
    v_cvt_pk_bf16_f32 v31, 0, v31
    v_mul_f32 v31, 0x3db504f3, v31
    v_cvt_pk_bf16_f32 v31, 0, v31
    s_waitcnt lgkmcnt(0)
    v_cvt_pk_bf16_f32 v56, 0, v56
    v_mul_f32 v56, 0x3db504f3, v56
    v_cvt_pk_bf16_f32 v56, 0, v56
    v_mul_f32 v56, s21, v56
    v_ceil_f32 v56, v56
    v_fma_f32 v24, v24, s21, -v56
    v_fma_f32 v25, v25, s21, -v56
    v_fma_f32 v26, v26, s21, -v56
    v_fma_f32 v27, v27, s21, -v56
    v_fma_f32 v28, v28, s21, -v56
    v_fma_f32 v29, v29, s21, -v56
    v_fma_f32 v30, v30, s21, -v56
    v_fma_f32 v31, v31, s21, -v56
    v_exp_f32 v24, v24
    v_exp_f32 v25, v25
    v_exp_f32 v26, v26
    v_exp_f32 v27, v27
    v_exp_f32 v28, v28
    v_exp_f32 v29, v29
    v_exp_f32 v30, v30
    v_exp_f32 v31, v31
    s_nop 0
    v_cvt_pk_bf16_f32 v40, v24, v25
    v_cvt_pk_bf16_f32 v41, v26, v27
    v_cvt_pk_bf16_f32 v42, v28, v29
    v_cvt_pk_bf16_f32 v43, v30, v31
    ds_write_b128 v12, v[40:43]
    s_nop 0
    v_mfma_f32_16x16x32_bf16 v[32:35], v[20:23], v[40:43], 0
    v_mfma_f32_16x16x32_bf16 v[64:67], a[128:131], v[40:43], 0
    v_mfma_f32_16x16x32_bf16 v[68:71], a[132:135], v[40:43], 0
    v_mfma_f32_16x16x32_bf16 v[72:75], a[136:139], v[40:43], 0
    s_waitcnt lgkmcnt(0)
    s_barrier
    ds_read_b128 v[44:47], v13
    ds_read_b128 v[48:51], v14
    ds_read_b128 v[52:55], v15
    v_mfma_f32_16x16x32_bf16 v[76:79], a[140:143], v[40:43], 0
    v_mfma_f32_16x16x32_bf16 v[80:83], a[144:147], v[40:43], 0
    v_mfma_f32_16x16x32_bf16 v[84:87], a[148:151], v[40:43], 0
    v_mfma_f32_16x16x32_bf16 v[88:91], a[152:155], v[40:43], 0
    v_mfma_f32_16x16x32_bf16 v[92:95], a[156:159], v[40:43], 0
    s_waitcnt lgkmcnt(2)
    v_mfma_f32_16x16x32_bf16 v[32:35], v[20:23], v[44:47], v[32:35]
    s_waitcnt lgkmcnt(1)
    v_mfma_f32_16x16x32_bf16 v[32:35], v[20:23], v[48:51], v[32:35]
    s_waitcnt lgkmcnt(0)
    v_mfma_f32_16x16x32_bf16 v[32:35], v[20:23], v[52:55], v[32:35]
    v_mfma_f32_16x16x32_bf16 v[64:67], a[160:163], v[44:47], v[64:67]
    v_mfma_f32_16x16x32_bf16 v[64:67], a[192:195], v[48:51], v[64:67]
    v_mfma_f32_16x16x32_bf16 v[64:67], a[224:227], v[52:55], v[64:67]
    s_cmp_lg_u32 s3, 0
    s_cbranch_scc1 A_noml
    s_nop 2
    v_mov_b32_e64 v57, v32
    s_mov_b64 exec, 0xffff
    buffer_store_dwordx4 v[56:59], v16, s[52:55], 0 offen sc1
    s_mov_b64 exec, -1
A_noml:
    v_mfma_f32_16x16x32_bf16 v[68:71], a[164:167], v[44:47], v[68:71]
    v_mfma_f32_16x16x32_bf16 v[68:71], a[196:199], v[48:51], v[68:71]
    v_mfma_f32_16x16x32_bf16 v[68:71], a[228:231], v[52:55], v[68:71]
    v_mfma_f32_16x16x32_bf16 v[72:75], a[168:171], v[44:47], v[72:75]
    v_mfma_f32_16x16x32_bf16 v[72:75], a[200:203], v[48:51], v[72:75]
    v_mfma_f32_16x16x32_bf16 v[72:75], a[232:235], v[52:55], v[72:75]
    v_perm_b32 v96, v65, v64, s63
    v_bfi_b32 v96, s61, v184, v96
    v_mfma_f32_16x16x32_bf16 v[76:79], a[172:175], v[44:47], v[76:79]
    v_perm_b32 v97, v67, v66, s63
    v_bfi_b32 v97, s61, v185, v97
    v_mfma_f32_16x16x32_bf16 v[76:79], a[204:207], v[48:51], v[76:79]
    v_perm_b32 v98, v69, v68, s63
    v_bfi_b32 v98, s61, v186, v98
    v_mfma_f32_16x16x32_bf16 v[76:79], a[236:239], v[52:55], v[76:79]
    v_perm_b32 v99, v71, v70, s63
    v_bfi_b32 v99, s61, v187, v99
    v_mfma_f32_16x16x32_bf16 v[80:83], a[176:179], v[44:47], v[80:83]
    buffer_store_dwordx4 v[96:99], v17, s[52:55], 0 offen offset:0 sc1
    v_perm_b32 v100, v73, v72, s63
    v_mfma_f32_16x16x32_bf16 v[80:83], a[208:211], v[48:51], v[80:83]
    v_bfi_b32 v100, s61, v184, v100
    v_perm_b32 v101, v75, v74, s63
    v_mfma_f32_16x16x32_bf16 v[80:83], a[240:243], v[52:55], v[80:83]
    v_bfi_b32 v101, s61, v185, v101
    v_perm_b32 v102, v77, v76, s63
    v_mfma_f32_16x16x32_bf16 v[84:87], a[180:183], v[44:47], v[84:87]
    v_bfi_b32 v102, s61, v186, v102
    v_perm_b32 v103, v79, v78, s63
    v_mfma_f32_16x16x32_bf16 v[84:87], a[212:215], v[48:51], v[84:87]
    v_bfi_b32 v103, s61, v187, v103
    buffer_store_dwordx4 v[100:103], v17, s[52:55], 0 offen offset:256 sc1
    v_mfma_f32_16x16x32_bf16 v[84:87], a[244:247], v[52:55], v[84:87]
    v_mfma_f32_16x16x32_bf16 v[88:91], a[184:187], v[44:47], v[88:91]
    v_perm_b32 v104, v81, v80, s63
    v_bfi_b32 v104, s61, v184, v104
    v_mfma_f32_16x16x32_bf16 v[88:91], a[216:219], v[48:51], v[88:91]
    v_perm_b32 v105, v83, v82, s63
    v_bfi_b32 v105, s61, v185, v105
    v_mfma_f32_16x16x32_bf16 v[88:91], a[248:251], v[52:55], v[88:91]
    v_mfma_f32_16x16x32_bf16 v[92:95], a[188:191], v[44:47], v[92:95]
    v_perm_b32 v106, v85, v84, s63
    v_bfi_b32 v106, s61, v186, v106
    v_mfma_f32_16x16x32_bf16 v[92:95], a[220:223], v[48:51], v[92:95]
    v_perm_b32 v107, v87, v86, s63
    v_bfi_b32 v107, s61, v187, v107
    v_mfma_f32_16x16x32_bf16 v[92:95], a[252:255], v[52:55], v[92:95]
    buffer_store_dwordx4 v[104:107], v17, s[52:55], 0 offen offset:512 sc1
    v_perm_b32 v108, v89, v88, s63
    v_bfi_b32 v108, s61, v184, v108
    v_perm_b32 v109, v91, v90, s63
    v_bfi_b32 v109, s61, v185, v109
    s_nop 2
    v_perm_b32 v110, v93, v92, s63
    v_bfi_b32 v110, s61, v186, v110
    v_perm_b32 v111, v95, v94, s63
    v_bfi_b32 v111, s61, v187, v111
    buffer_store_dwordx4 v[108:111], v17, s[52:55], 0 offen offset:768 sc1
    s_barrier
    s_mov_b32 s6, 65536
    buffer_load_dwordx4 v[208:211], v183, s[44:47], s6 offen nt
    s_mov_b32 s6, 73728
    buffer_load_dwordx4 v[212:215], v183, s[44:47], s6 offen nt
    s_mov_b32 s6, 81920
    buffer_load_dwordx4 v[216:219], v183, s[44:47], s6 offen nt
    s_mov_b32 s6, 90112
    buffer_load_dwordx4 v[220:223], v183, s[44:47], s6 offen nt
    s_lshl_b32 s6, s32, 12
    s_lshl_b32 s7, s33, 4
    s_add_u32 s6, s6, s7
    s_add_u32 s6, s6, 786432
    v_lshl_add_u32 v237, v3, 8, s6
    v_lshrrev_b32 v9, 2, v0
    s_lshl_b32 s6, s3, 7
    s_add_u32 s6, s6, 1024
    v_lshlrev_b32 v8, 9, v7
    v_lshl_add_u32 v8, v9, 3, v8
    v_add_u32 v8, s6, v8
    s_lshl_b32 s6, s3, 9
    s_add_u32 s6, s6, 1024
    v_lshl_add_u32 v238, v0, 3, s6
    s_lshl_b32 s6, s4, 12
    s_lshl_b32 s7, s33, 8
    s_add_u32 s6, s6, s7
    s_lshl_b32 s7, s3, 19
    s_add_u32 s6, s6, s7
    s_add_u32 s6, s6, 2097152
    v_xor_b32 v9, v3, v2
    v_lshlrev_b32 v9, 4, v9
    v_lshl_add_u32 v9, v2, 15, v9
    v_add_u32 v240, s6, v9
    v_xor_b32 v241, 0x80, v240
    s_mov_b32 s40, 130048
    s_mov_b32 s41, 260096
    s_mov_b32 s42, 390144
    s_lshl_b32 s6, s3, 12
    s_add_u32 s6, s6, 4096
    s_mov_b32 m0, s6
    v_and_b32 v9, 7, v0
    v_lshrrev_b32 v9, v9, v58
    v_and_b32 v9, 1, v9
    v_xor_b32 v9, 1, v9
    v_mul_u32_u24 v242, 0x10001, v9
    v_mov_b32 v243, 512
    v_mov_b32 v9, 0
    ds_write_b32 v243, v9
    v_xor_b32 v9, s3, v1
    v_lshl_add_u32 v9, v10, 3, v9
    v_lshrrev_b32 v11, 1, v7
    v_lshl_add_u32 v9, v11, 2, v9
    v_lshlrev_b32 v9, 4, v9
    v_and_b32 v11, 1, v0
    v_lshl_add_u32 v9, v11, 3, v9
    v_lshl_add_u32 v11, v2, 3, v1
    v_lshl_add_u32 v9, v11, 8, v9
    v_add_u32 v244, 4096, v9
    v_xor_b32 v245, 0x80, v244
    s_lshl_b32 s6, s3, 7
    s_add_u32 s6, s6, 0
    v_lshl_add_u32 v12, v0, 1, s6
    v_lshl_add_u32 v13, v2, 4, s6
    v_lshl_add_u32 v231, v7, 4, v2
    v_lshlrev_b32 v231, 2, v231
    v_mov_b32 v246, 0x800
    s_lshl_b32 s69, s4, 2
    s_add_u32 s69, s69, s5
    s_sub_u32 s69, s69, 12
    s_cmp_ge_u32 s5, 12
    s_cselect_b32 s69, s69, 99
    s_cmp_eq_u32 s3, 0
    s_cselect_b32 s69, s69, 99
    s_and_b32 s6, s69, 31
    s_lshl_b32 s6, s6, 5
    v_lshl_add_u32 v230, v2, 2, v7
    v_lshl_add_u32 v230, v230, 1, s6
    v_lshrrev_b32 v234, 2, v0
    v_min_u32 v235, 5, v234
    v_lshlrev_b32 v234, 11, v234
    v_lshlrev_b32 v235, 11, v235
    v_lshl_add_u32 v234, v7, 4, v234
    v_lshl_add_u32 v235, v7, 4, v235
    s_lshl_b32 s6, s6, 1
    s_add_u32 s7, s6, 262144
    v_add_u32 v236, s7, v234
    s_add_u32 s7, s6, 524288
    v_add_u32 v234, s7, v234
    v_add_u32 v235, s7, v235
    s_branch A_comb
    s_endpgm
.p2align 12
A_comb:
    s_waitcnt vmcnt(5)
A_pollml:
    buffer_load_dwordx4 v[16:19], v239, s[52:55], 0 offen sc1
    s_add_u32 s64, s64, 1
    s_cmp_gt_u32 s64, 1048576
    s_cbranch_scc1 L_end
A_pollml1:
    s_waitcnt vmcnt(0)
    ds_write_b64 v8, v[16:17]
    v_cmp_ne_u32 vcc, s56, v18
    s_cbranch_vccnz A_pollml
A_gotml:
    s_barrier
    buffer_load_dwordx4 v240, s[52:55], 0 offen offset:0 sc1 lds
    buffer_load_dwordx4 v240, s[52:55], s40 offen offset:1024 sc1 lds
    buffer_load_dwordx4 v241, s[52:55], s41 offen offset:2048 sc1 lds
    buffer_load_dwordx4 v241, s[52:55], s42 offen offset:3072 sc1 lds
    s_waitcnt lgkmcnt(0)
    s_barrier
    ds_read_b64 v[16:17], v238
    s_waitcnt lgkmcnt(0)
    v_mov_b32 v20, v16
    s_nop 1
    v_max_f32_dpp v20, v20, v20 quad_perm:[1,0,3,2] row_mask:0xf bank_mask:0xf
    s_nop 1
    v_max_f32_dpp v20, v20, v20 quad_perm:[2,3,0,1] row_mask:0xf bank_mask:0xf
    s_nop 1
    v_max_f32_dpp v20, v20, v20 row_ror:4 row_mask:0xf bank_mask:0xf
    s_nop 1
    v_max_f32_dpp v20, v20, v20 row_ror:8 row_mask:0xf bank_mask:0xf
    v_mov_b32 v21, v20
    s_nop 1
    v_permlane16_swap_b32 v21, v20
    v_max_f32 v20, v20, v21
    v_mov_b32 v21, v20
    s_nop 1
    v_permlane32_swap_b32 v21, v20
    v_max_f32 v20, v20, v21
    v_sub_f32 v16, v16, v20
    v_exp_f32 v16, v16
    s_nop 0
    v_cvt_pk_bf16_f32 v16, 0, v16
    ds_write_b16_d16_hi v12, v16
    ds_read_b128 v[24:27], v13
    ds_read_b128 v[28:31], v13 offset:64
    v_mul_f32 v17, v17, v16
    s_nop 1
    v_add_f32_dpp v17, v17, v17 quad_perm:[1,0,3,2] row_mask:0xf bank_mask:0xf
    s_nop 1
    v_add_f32_dpp v17, v17, v17 quad_perm:[2,3,0,1] row_mask:0xf bank_mask:0xf
    s_nop 1
    v_add_f32_dpp v17, v17, v17 row_ror:4 row_mask:0xf bank_mask:0xf
    s_nop 1
    v_add_f32_dpp v17, v17, v17 row_ror:8 row_mask:0xf bank_mask:0xf
    v_mov_b32 v21, v17
    s_nop 1
    v_permlane16_swap_b32 v21, v17
    v_add_f32 v17, v17, v21
    v_mov_b32 v21, v17
    s_nop 1
    v_permlane32_swap_b32 v21, v17
    v_add_f32 v17, v17, v21
    v_rcp_f32 v17, v17
    v_perm_b32 v32, v196, v192, s100
    v_perm_b32 v33, v204, v200, s100
    v_perm_b32 v34, v212, v208, s100
    v_perm_b32 v35, v220, v216, s100
    v_perm_b32 v36, v196, v192, s63
    v_perm_b32 v37, v204, v200, s63
    v_perm_b32 v38, v212, v208, s63
    v_perm_b32 v39, v220, v216, s63
    v_perm_b32 v40, v197, v193, s100
    v_perm_b32 v41, v205, v201, s100
    v_perm_b32 v42, v213, v209, s100
    v_perm_b32 v43, v221, v217, s100
    v_perm_b32 v44, v197, v193, s63
    v_perm_b32 v45, v205, v201, s63
    v_perm_b32 v46, v213, v209, s63
    v_perm_b32 v47, v221, v217, s63
    v_perm_b32 v48, v198, v194, s100
    v_perm_b32 v49, v206, v202, s100
    v_perm_b32 v50, v214, v210, s100
    v_perm_b32 v51, v222, v218, s100
    v_perm_b32 v52, v198, v194, s63
    v_perm_b32 v53, v206, v202, s63
    v_perm_b32 v54, v214, v210, s63
    v_perm_b32 v55, v222, v218, s63
    v_perm_b32 v56, v199, v195, s100
    v_perm_b32 v57, v207, v203, s100
    v_perm_b32 v58, v215, v211, s100
    v_perm_b32 v59, v223, v219, s100
    v_perm_b32 v60, v199, v195, s63
    v_perm_b32 v61, v207, v203, s63
    v_perm_b32 v62, v215, v211, s63
    v_perm_b32 v63, v223, v219, s63
A_gcheck:
    s_waitcnt vmcnt(0) lgkmcnt(0)
    s_barrier
    ds_read_b64_tr_b16 v[96:97], v244 offset:0
    ds_read_b64_tr_b16 v[98:99], v244 offset:1024
    ds_read_b64_tr_b16 v[100:101], v244 offset:8192
    ds_read_b64_tr_b16 v[102:103], v244 offset:9216
    ds_read_b64_tr_b16 v[104:105], v245 offset:0
    ds_read_b64_tr_b16 v[106:107], v245 offset:1024
    ds_read_b64_tr_b16 v[108:109], v245 offset:8192
    ds_read_b64_tr_b16 v[110:111], v245 offset:9216
    s_waitcnt lgkmcnt(6)
    v_xor_b32 v96, v242, v96
    v_xor_b32 v97, v242, v97
    v_xor_b32 v98, v242, v98
    v_xor_b32 v99, v242, v99
    v_bitop3_b32 v21, s61, v96, v97 bitop3:0x80
    v_bitop3_b32 v21, v21, v98, v99 bitop3:0x80
    v_mfma_f32_16x16x32_bf16 v[112:115], v[96:99], v[24:27], 0
    s_waitcnt lgkmcnt(4)
    v_xor_b32 v100, v242, v100
    v_xor_b32 v101, v242, v101
    v_xor_b32 v102, v242, v102
    v_xor_b32 v103, v242, v103
    v_bitop3_b32 v21, v21, v100, v101 bitop3:0x80
    v_bitop3_b32 v21, v21, v102, v103 bitop3:0x80
    v_mfma_f32_16x16x32_bf16 v[112:115], v[100:103], v[28:31], v[112:115]
    s_waitcnt lgkmcnt(2)
    v_xor_b32 v104, v242, v104
    v_xor_b32 v105, v242, v105
    v_xor_b32 v106, v242, v106
    v_xor_b32 v107, v242, v107
    v_bitop3_b32 v21, v21, v104, v105 bitop3:0x80
    v_bitop3_b32 v21, v21, v106, v107 bitop3:0x80
    v_mfma_f32_16x16x32_bf16 v[116:119], v[104:107], v[24:27], 0
    s_waitcnt lgkmcnt(0)
    v_xor_b32 v108, v242, v108
    v_xor_b32 v109, v242, v109
    v_xor_b32 v110, v242, v110
    v_xor_b32 v111, v242, v111
    v_bitop3_b32 v21, v21, v108, v109 bitop3:0x80
    v_bitop3_b32 v21, v21, v110, v111 bitop3:0x80
    v_mfma_f32_16x16x32_bf16 v[116:119], v[108:111], v[28:31], v[116:119]
    v_cmp_ne_u32 vcc, s61, v21
    v_mul_f32 v112, v112, v17
    v_mul_f32 v113, v113, v17
    v_mul_f32 v114, v114, v17
    v_mul_f32 v115, v115, v17
    v_cvt_pk_bf16_f32 v120, v112, v113
    v_cvt_pk_bf16_f32 v121, v114, v115
    s_cbranch_vccz A_clean
    ds_write_b32 v243, v243
    s_waitcnt lgkmcnt(0)
A_clean:
    v_mul_f32 v116, v116, v17
    v_mul_f32 v117, v117, v17
    v_mul_f32 v118, v118, v17
    v_mul_f32 v119, v119, v17
    v_cvt_pk_bf16_f32 v122, v116, v117
    v_cvt_pk_bf16_f32 v123, v118, v119
    s_barrier
    ds_read_b32 v22, v243
    v_mfma_f32_16x16x32_bf16 v[128:131], v[120:123], v[32:35], 0
    v_mfma_f32_16x16x32_bf16 v[132:135], v[120:123], v[36:39], 0
    v_mfma_f32_16x16x32_bf16 v[136:139], v[120:123], v[40:43], 0
    v_mfma_f32_16x16x32_bf16 v[140:143], v[120:123], v[44:47], 0
    v_mfma_f32_16x16x32_bf16 v[144:147], v[120:123], v[48:51], 0
    v_mfma_f32_16x16x32_bf16 v[148:151], v[120:123], v[52:55], 0
    v_mfma_f32_16x16x32_bf16 v[152:155], v[120:123], v[56:59], 0
    v_mfma_f32_16x16x32_bf16 v[156:159], v[120:123], v[60:63], 0
    s_waitcnt lgkmcnt(0)
    v_cmp_ne_u32 vcc, 0, v22
    s_cbranch_vccz A_gok
    s_barrier
    v_mov_b32 v22, 0
    ds_write_b32 v243, v22
    buffer_load_dwordx4 v240, s[52:55], 0 offen offset:0 sc1 lds
    buffer_load_dwordx4 v240, s[52:55], s40 offen offset:1024 sc1 lds
    buffer_load_dwordx4 v241, s[52:55], s41 offen offset:2048 sc1 lds
    buffer_load_dwordx4 v241, s[52:55], s42 offen offset:3072 sc1 lds
    s_add_u32 s64, s64, 1
    s_cmp_gt_u32 s64, 1048576
    s_cbranch_scc1 L_end
    s_branch A_gcheck
A_gok:
    s_mov_b64 exec, 0xffff
    v_cvt_pk_bf16_f32 v124, v128, v132
    v_or_b32 v124, 1, v124
    v_cvt_pk_bf16_f32 v125, v136, v140
    v_cvt_pk_bf16_f32 v126, v144, v148
    v_cvt_pk_bf16_f32 v127, v152, v156
    buffer_store_dwordx4 v[124:127], v237, s[52:55], 0 offen
    s_barrier
    s_mov_b64 exec, -1
    s_cmp_gt_u32 s69, 31
    s_cbranch_scc1 A_nomp
    v_mov_b32 v232, 0
    v_mov_b32 v233, 0
    global_load_short_d16_hi v232, v230, s[8:9]
    global_load_short_d16_hi v233, v230, s[28:29]
    s_mov_b32 s6, 0
    buffer_load_dwordx4 v[64:67], v234, s[52:55], s6 offen sc1
    s_mov_b32 s6, 32768
    buffer_load_dwordx4 v[68:71], v234, s[52:55], s6 offen sc1
    s_mov_b32 s6, 65536
    buffer_load_dwordx4 v[72:75], v234, s[52:55], s6 offen sc1
    s_mov_b32 s6, 98304
    buffer_load_dwordx4 v[76:79], v234, s[52:55], s6 offen sc1
    s_mov_b32 s6, 131072
    buffer_load_dwordx4 v[80:83], v234, s[52:55], s6 offen sc1
    s_mov_b32 s6, 163840
    buffer_load_dwordx4 v[84:87], v235, s[52:55], s6 offen sc1
A_nomp:
    s_mov_b64 exec, 0xffff
    buffer_store_dwordx4 v[124:127], v237, s[52:55], s101 offen sc1
    s_mov_b64 exec, -1
    s_cmp_gt_u32 s69, 31
    s_cbranch_scc1 A_done
    s_waitcnt vmcnt(1)
    s_branch R_pollm_have
R_pollm:
    s_mov_b32 s6, 0
    buffer_load_dwordx4 v[64:67], v234, s[52:55], s6 offen sc1
    s_mov_b32 s6, 32768
    buffer_load_dwordx4 v[68:71], v234, s[52:55], s6 offen sc1
    s_mov_b32 s6, 65536
    buffer_load_dwordx4 v[72:75], v234, s[52:55], s6 offen sc1
    s_mov_b32 s6, 98304
    buffer_load_dwordx4 v[76:79], v234, s[52:55], s6 offen sc1
    s_mov_b32 s6, 131072
    buffer_load_dwordx4 v[80:83], v234, s[52:55], s6 offen sc1
    s_mov_b32 s6, 163840
    buffer_load_dwordx4 v[84:87], v235, s[52:55], s6 offen sc1
    s_add_u32 s64, s64, 1
    s_cmp_gt_u32 s64, 1048576
    s_cbranch_scc1 L_end
    s_waitcnt vmcnt(0)
R_pollm_have:
    v_mov_b32 v88, 0
    v_mov_b32 v89, 0x800
    v_bitop3_b32 v88, v88, v64, s57 bitop3:0xf6
    v_bitop3_b32 v88, v88, v65, s57 bitop3:0xf6
    v_bitop3_b32 v88, v88, v66, s57 bitop3:0xf6
    v_bitop3_b32 v88, v88, v67, s57 bitop3:0xf6
    v_bitop3_b32 v88, v88, v68, s57 bitop3:0xf6
    v_bitop3_b32 v88, v88, v69, s57 bitop3:0xf6
    v_bitop3_b32 v88, v88, v70, s57 bitop3:0xf6
    v_bitop3_b32 v88, v88, v71, s57 bitop3:0xf6
    v_bitop3_b32 v88, v88, v72, s57 bitop3:0xf6
    v_bitop3_b32 v88, v88, v73, s57 bitop3:0xf6
    v_bitop3_b32 v88, v88, v74, s57 bitop3:0xf6
    v_bitop3_b32 v88, v88, v75, s57 bitop3:0xf6
    v_bitop3_b32 v88, v88, v76, s57 bitop3:0xf6
    v_bitop3_b32 v88, v88, v77, s57 bitop3:0xf6
    v_bitop3_b32 v88, v88, v78, s57 bitop3:0xf6
    v_bitop3_b32 v88, v88, v79, s57 bitop3:0xf6
    v_bitop3_b32 v88, v88, v80, s57 bitop3:0xf6
    v_bitop3_b32 v88, v88, v81, s57 bitop3:0xf6
    v_bitop3_b32 v88, v88, v82, s57 bitop3:0xf6
    v_bitop3_b32 v88, v88, v83, s57 bitop3:0xf6
    v_bitop3_b32 v88, v88, v84, s57 bitop3:0xf6
    v_bitop3_b32 v88, v88, v85, s57 bitop3:0xf6
    v_bitop3_b32 v88, v88, v86, s57 bitop3:0xf6
    v_bitop3_b32 v88, v88, v87, s57 bitop3:0xf6
    v_and_b32 v88, s62, v88
    v_cmp_ne_u32 vcc, 0, v88
    s_cbranch_vccnz R_pollm
    v_bfi_b32 v64, s62, v89, v64
    v_bfi_b32 v65, s62, v89, v65
    v_bfi_b32 v66, s62, v89, v66
    v_bfi_b32 v67, s62, v89, v67
    v_bfi_b32 v68, s62, v89, v68
    v_bfi_b32 v69, s62, v89, v69
    v_bfi_b32 v70, s62, v89, v70
    v_bfi_b32 v71, s62, v89, v71
    v_bfi_b32 v72, s62, v89, v72
    v_bfi_b32 v73, s62, v89, v73
    v_bfi_b32 v74, s62, v89, v74
    v_bfi_b32 v75, s62, v89, v75
    v_bfi_b32 v76, s62, v89, v76
    v_bfi_b32 v77, s62, v89, v77
    v_bfi_b32 v78, s62, v89, v78
    v_bfi_b32 v79, s62, v89, v79
    v_bfi_b32 v80, s62, v89, v80
    v_bfi_b32 v81, s62, v89, v81
    v_bfi_b32 v82, s62, v89, v82
    v_bfi_b32 v83, s62, v89, v83
    v_bfi_b32 v84, s62, v89, v84
    v_bfi_b32 v85, s62, v89, v85
    v_bfi_b32 v86, s62, v89, v86
    v_bfi_b32 v87, s62, v89, v87
    s_mov_b64 exec, 0xffffff
    v_add_f32 v64, v64, v84
    v_add_f32 v65, v65, v85
    v_add_f32 v66, v66, v86
    v_add_f32 v67, v67, v87
    s_mov_b64 exec, -1
    v_add_f32 v64, v64, v68
    v_add_f32 v65, v65, v69
    v_add_f32 v66, v66, v70
    v_add_f32 v67, v67, v71
    v_add_f32 v72, v72, v76
    v_add_f32 v73, v73, v77
    v_add_f32 v74, v74, v78
    v_add_f32 v75, v75, v79
    v_add_f32 v64, v64, v72
    v_add_f32 v65, v65, v73
    v_add_f32 v66, v66, v74
    v_add_f32 v67, v67, v75
    v_add_f32 v64, v64, v80
    v_add_f32 v65, v65, v81
    v_add_f32 v66, v66, v82
    v_add_f32 v67, v67, v83
    s_nop 1
    v_permlane32_swap_b32 v64, v66
    v_permlane32_swap_b32 v65, v67
    v_add_f32 v64, v64, v66
    v_add_f32 v65, v65, v67
    s_nop 1
    v_permlane16_swap_b32 v64, v65
    v_add_f32 v12, v64, v65
    s_nop 1
    v_add_f32_dpp v12, v12, v12 row_ror:4 row_mask:0xf bank_mask:0xf
    s_nop 1
    v_add_f32_dpp v12, v12, v12 row_ror:8 row_mask:0xf bank_mask:0xf
R_skip:
    ds_bpermute_b32 v12, v231, v12
    s_waitcnt lgkmcnt(0)
    v_cvt_pk_bf16_f32 v12, 0, v12
    v_add_f32 v12, v12, v233
    v_cvt_pk_bf16_f32 v12, 0, v12
    v_mul_f32 v13, 0xbfb8aa3b, v12
    v_exp_f32 v13, v13
    s_nop 0
    v_add_f32 v13, 1.0, v13
    v_rcp_f32 v13, v13
    s_nop 0
    v_mul_f32 v12, v12, v13
    v_cvt_pk_bf16_f32 v12, 0, v12
    s_mov_b32 s7, 0x8000
    buffer_load_dwordx4 v[32:35], v236, s[52:55], 0 offen sc1
    buffer_load_dwordx4 v[36:39], v236, s[52:55], s7 offen sc1
R_pollo:
    s_add_u32 s64, s64, 1
    s_cmp_gt_u32 s64, 1048576
    s_cbranch_scc1 L_end
    buffer_load_dwordx4 v[40:43], v236, s[52:55], 0 offen sc1
    buffer_load_dwordx4 v[44:47], v236, s[52:55], s7 offen sc1
    s_waitcnt vmcnt(2)
    v_bfi_b32 v24, s62, v246, v32
    v_bfi_b32 v28, s62, v246, v36
    v_bfi_b32 v26, s62, v246, v34
    v_bfi_b32 v29, s62, v246, v38
    v_add_f32 v24, v24, v28
    v_add_f32 v26, v26, v29
    v_add_f32 v25, v33, v37
    v_add_f32 v27, v35, v39
    v_permlane32_swap_b32 v24, v26
    v_xor_b32 v21, s57, v32
    v_permlane32_swap_b32 v25, v27
    v_add_f32 v24, v24, v26
    v_add_f32 v25, v25, v27
    v_bitop3_b32 v21, v21, v34, s57 bitop3:0xf6
    v_bitop3_b32 v21, v21, v36, s57 bitop3:0xf6
    v_permlane16_swap_b32 v24, v25
    v_add_f32 v13, v24, v25
    v_bitop3_b32 v21, v21, v38, s57 bitop3:0xf6
    v_and_b32 v21, s62, v21
    v_add_f32_dpp v13, v13, v13 row_ror:4 row_mask:0xf bank_mask:0xf
    v_cmp_ne_u32 vcc, 0, v21
    s_nop 0
    v_add_f32_dpp v13, v13, v13 row_ror:8 row_mask:0xf bank_mask:0xf
    v_cvt_pk_bf16_f32 v13, 0, v13
    v_mul_f32 v13, v13, v12
    v_cvt_pk_bf16_f32 v13, 0, v13
    v_add_f32 v13, v13, v232
    v_cvt_pk_bf16_f32 v13, 0, v13
    s_cbranch_vccz R_goto
    buffer_load_dwordx4 v[32:35], v236, s[52:55], 0 offen sc1
    buffer_load_dwordx4 v[36:39], v236, s[52:55], s7 offen sc1
    s_waitcnt vmcnt(2)
    v_bfi_b32 v24, s62, v246, v40
    v_bfi_b32 v28, s62, v246, v44
    v_bfi_b32 v26, s62, v246, v42
    v_bfi_b32 v29, s62, v246, v46
    v_add_f32 v24, v24, v28
    v_add_f32 v26, v26, v29
    v_add_f32 v25, v41, v45
    v_add_f32 v27, v43, v47
    v_permlane32_swap_b32 v24, v26
    v_xor_b32 v21, s57, v40
    v_permlane32_swap_b32 v25, v27
    v_add_f32 v24, v24, v26
    v_add_f32 v25, v25, v27
    v_bitop3_b32 v21, v21, v42, s57 bitop3:0xf6
    v_bitop3_b32 v21, v21, v44, s57 bitop3:0xf6
    v_permlane16_swap_b32 v24, v25
    v_add_f32 v13, v24, v25
    v_bitop3_b32 v21, v21, v46, s57 bitop3:0xf6
    v_and_b32 v21, s62, v21
    v_add_f32_dpp v13, v13, v13 row_ror:4 row_mask:0xf bank_mask:0xf
    v_cmp_ne_u32 vcc, 0, v21
    s_nop 0
    v_add_f32_dpp v13, v13, v13 row_ror:8 row_mask:0xf bank_mask:0xf
    v_cvt_pk_bf16_f32 v13, 0, v13
    v_mul_f32 v13, v13, v12
    v_cvt_pk_bf16_f32 v13, 0, v13
    v_add_f32 v13, v13, v232
    v_cvt_pk_bf16_f32 v13, 0, v13
    s_cbranch_vccnz R_pollo
R_goto:
    s_mov_b32 exec_lo, 0x000f000f
    s_mov_b32 exec_hi, 0x000f000f
    global_store_short_d16_hi v230, v13, s[30:31]
    s_cmp_lg_u32 s69, 0
    s_cbranch_scc1 A_done
    s_mov_b64 exec, 1
    v_mov_b32 v5, 0
    v_mov_b32 v7, s56
    global_store_dword v5, v7, s[34:35]
A_done:
L_last:
    s_endpgm
.section .rodata,"a"
.p2align 6
.amdhsa_kernel recurrent_scan__compressed_kv_cla__mixer_channel_mlp__decode_kernel
  .amdhsa_next_free_vgpr 512
  .amdhsa_next_free_sgpr 102
  .amdhsa_accum_offset 256
  .amdhsa_group_segment_fixed_size 0
  .amdhsa_kernarg_size 112
  .amdhsa_user_sgpr_count 2
  .amdhsa_user_sgpr_kernarg_segment_ptr 1
  .amdhsa_system_sgpr_workgroup_id_x 1
.end_amdhsa_kernel
```
